```python
import torch

def _softmax(x, axis=-1):
    return torch.softmax(x, dim=axis)
def _gelu(x):
    return torch.nn.functional.gelu(x, approximate="tanh")
def _silu(x):
    return torch.nn.functional.silu(x)
def _sigmoid(x):
    return torch.sigmoid(x)
def _layernorm(x, axis=-1, eps=1e-5):
    m = x.mean(dim=axis, keepdim=True)
    v = x.var(dim=axis, keepdim=True, unbiased=False)
    return (x - m) / torch.sqrt(v + eps)
def _scatter_add(tgt, idx, src, axis=0):
    return tgt.clone().index_add_(axis, idx, src)
def _segment_sum(src, seg, n):
    out = torch.zeros((n,) + src.shape[1:], dtype=src.dtype)
    return out.index_add_(0, seg, src)
def _pad(x, pw):
    flat = tuple(v for pair in reversed(pw) for v in pair)
    return torch.nn.functional.pad(x, flat)

kernel_name = 'sequential_preLN__sliding_block__dense_activation_squared_relu__prompt'

def setup_inputs():

    _w = (lambda a: (lambda t: t.to(torch.bfloat16) if t.is_floating_point() else t)(torch.as_tensor(a)))
    def _A_setup():
        B, S, D = 1, 2048, 512
        return {
            "x": _w((lambda *s: torch.randn(*s, dtype=torch.bfloat16) * 0.05)(B, S, D)),
            "wqkv": _w((lambda *s: torch.randn(*s, dtype=torch.bfloat16) * 0.05)(D, 3 * D)),
            "wo": _w((lambda *s: torch.randn(*s, dtype=torch.bfloat16) * 0.05)(D, D)),
        }
    _A_in = _A_setup()

    def _B_setup():
        B, S, D, F = 1, 2048, 512, 1792
        return {
            "x": _w((lambda *s: torch.randn(*s, dtype=torch.bfloat16) * 0.05)(B, S, D)),
            "w1": _w((lambda *s: torch.randn(*s, dtype=torch.bfloat16) * 0.05)(D, F)),
            "b1": _w((lambda *s: torch.randn(*s, dtype=torch.bfloat16) * 0.4)(F)),
            "w2": _w((lambda *s: torch.randn(*s, dtype=torch.bfloat16) * 0.05)(F, D)),
            "b2": _w((lambda *s: torch.randn(*s, dtype=torch.bfloat16) * 1.6)(D)),
        }
    _B_in = _B_setup()

    return {
        "A_x": _A_in["x"],
        "A_wqkv": _A_in["wqkv"],
        "A_wo": _A_in["wo"],
        "B_x": _B_in["x"],
        "B_w1": _B_in["w1"],
        "B_b1": _B_in["b1"],
        "B_w2": _B_in["w2"],
        "B_b2": _B_in["b2"],
    }

def reference(A_x, A_wqkv, A_wo, B_x, B_w1, B_b1, B_w2, B_b2):
    def _A_ref(x, wqkv, wo):
        B, S, D = x.shape
        H = 32; Dh = D // H; W = 256
        qkv = (lambda x, *d: x.permute(*d))((x @ wqkv).reshape(B, S, 3, H, Dh), 2, 0, 3, 1, 4)
        q, k, v = qkv[0], qkv[1], qkv[2]
        scores = torch.einsum("bhqd,bhkd->bhqk", q, k) * (Dh ** -0.5)
        idx = torch.arange(S)
        mask = (idx[:, None] - idx[None, :] >= 0) & (idx[:, None] - idx[None, :] < W)
        scores = torch.where(mask[None, None], scores, -1e9)
        p = _softmax(scores, axis=-1)
        o = torch.einsum("bhqk,bhkd->bhqd", p, v)
        return (lambda x, *d: x.permute(*d))(o, 0, 2, 1, 3).reshape(B, S, D) @ wo

    def _B_ref(x, w1, b1, w2, b2):
        h = torch.einsum("bsd,df->bsf", x, w1) + b1
        zero = torch.zeros_like(h)
        r = torch.where(h > zero, h, zero)
        h = r * r
        out = torch.einsum("bsf,fd->bsd", h, w2) + b2
        return out

    x = A_x
    h = x + _A_ref(_layernorm(x, axis=-1), A_wqkv, A_wo)
    h2 = h + _B_ref(_layernorm(h, axis=-1), B_w1, B_b1, B_w2, B_b2)
    return h2
```

```asm
; @launch grid=(256,1,1) block=(512,1,1) lds=163840
.amdgcn_target "amdgcn-amd-amdhsa--gfx950"
.text
.globl sequential_preLN__sliding_block__dense_activation_squared_relu__prompt_kernel
.p2align 8
.type sequential_preLN__sliding_block__dense_activation_squared_relu__prompt_kernel,@function
sequential_preLN__sliding_block__dense_activation_squared_relu__prompt_kernel:
    s_cmp_ge_u32 s2, 256
    s_cbranch_scc1 Lend
    s_load_dwordx16 s[64:79], s[0:1], 0
    s_load_dwordx4 s[80:83], s[0:1], 64
    s_load_dwordx2 s[84:85], s[0:1], 80
    v_lshrrev_b32 v2, 6, v0
    v_and_b32 v1, 63, v0
    v_readfirstlane_b32 s46, v2
    s_bfe_u32 s48, s2, 0x20001
    s_lshl_b32 s48, s48, 2
    s_bfe_u32 s49, s2, 0x20003
    s_or_b32 s44, s48, s49
    s_and_b32 s48, s2, 1
    s_lshl_b32 s48, s48, 3
    s_lshr_b32 s49, s2, 5
    s_or_b32 s45, s48, s49
    s_add_u32 s99, s45, s44
    s_lshl_b32 s96, s2, 7
    s_add_u32 s96, s96, 16056320
    s_waitcnt lgkmcnt(0)
    s_mov_b32 s4, s64
    s_and_b32 s5, s65, 0xffff
    s_mov_b32 s6, 2097152
    s_mov_b32 s7, 0x20000
    s_mov_b32 s8, s66
    s_and_b32 s9, s67, 0xffff
    s_mov_b32 s10, 1572864
    s_mov_b32 s11, 0x20000
    s_mov_b32 s40, s84
    s_and_b32 s41, s85, 0xffff
    s_mov_b32 s42, 16089088
    s_mov_b32 s43, 0x20000
    s_mov_b32 s36, s82
    s_and_b32 s37, s83, 0xffff
    s_mov_b32 s38, 256
    s_mov_b32 s39, 0x20000
    s_or_b32 s48, s2, s46
    s_cmp_lg_u32 s48, 0
    s_cbranch_scc1 Lnoscan1
    v_lshlrev_b32 v2, 6, v1
    s_mov_b32 s48, 0
    buffer_load_dword v116, v2, s[40:43], s48 offen sc1
    s_mov_b32 s48, 4096
    buffer_load_dword v117, v2, s[40:43], s48 offen sc1
    s_mov_b32 s48, 8192
    buffer_load_dword v118, v2, s[40:43], s48 offen sc1
    s_mov_b32 s48, 12288
    buffer_load_dword v119, v2, s[40:43], s48 offen sc1
    s_mov_b32 s48, 16384
    buffer_load_dword v120, v2, s[40:43], s48 offen sc1
    s_mov_b32 s48, 20480
    buffer_load_dword v121, v2, s[40:43], s48 offen sc1
    s_mov_b32 s48, 24576
    buffer_load_dword v122, v2, s[40:43], s48 offen sc1
    s_mov_b32 s48, 28672
    buffer_load_dword v123, v2, s[40:43], s48 offen sc1
    s_mov_b32 s48, 32768
    buffer_load_dword v124, v2, s[40:43], s48 offen sc1
    s_mov_b32 s48, 36864
    buffer_load_dword v125, v2, s[40:43], s48 offen sc1
    s_mov_b32 s48, 40960
    buffer_load_dword v126, v2, s[40:43], s48 offen sc1
    s_mov_b32 s48, 45056
    buffer_load_dword v127, v2, s[40:43], s48 offen sc1
    s_mov_b32 s48, 49152
    buffer_load_dword v128, v2, s[40:43], s48 offen sc1
    s_mov_b32 s48, 53248
    buffer_load_dword v129, v2, s[40:43], s48 offen sc1
    s_mov_b32 s48, 57344
    buffer_load_dword v130, v2, s[40:43], s48 offen sc1
    s_mov_b32 s48, 61440
    buffer_load_dword v131, v2, s[40:43], s48 offen sc1
Lnoscan1:
    s_lshl_b32 s48, s44, 7
    s_lshl_b32 s49, s46, 4
    s_add_u32 s48, s48, s49
    v_lshrrev_b32 v5, 3, v1
    v_add_u32 v5, s48, v5
    v_lshlrev_b32 v5, 10, v5
    v_lshrrev_b32 v6, 4, v1
    v_and_b32 v7, 7, v1
    v_xor_b32 v8, v6, v7
    v_lshl_add_u32 v2, v8, 4, v5
    v_xor_b32 v8, 4, v8
    v_lshl_add_u32 v3, v8, 4, v5
    v_add_u32 v3, 8192, v3
    v_lshrrev_b32 v5, 2, v1
    v_mul_u32_u24 v5, 3072, v5
    v_and_b32 v6, 3, v1
    v_lshl_add_u32 v4, v6, 4, v5
    s_and_b32 s50, s46, 3
    s_mul_i32 s51, s50, 49152
    s_lshl_b32 s52, s45, 6
    s_add_u32 s51, s51, s52
    s_lshl_b32 s52, s46, 11
    s_lshl_b32 s53, s50, 10
    s_cmp_ge_u32 s46, 4
    s_cbranch_scc1 Lrole1
    s_add_u32 s57, s99, 0
    s_and_b32 s57, s57, 7
    s_lshl_b32 s55, s57, 7
    s_add_u32 s56, s52, 0
    s_mov_b32 m0, s56
    s_nop 0
    buffer_load_dwordx4 v2, s[4:7], s55 offen lds
    s_add_u32 s57, s99, 0
    s_and_b32 s57, s57, 7
    s_lshl_b32 s55, s57, 7
    s_add_u32 s56, s52, 1024
    s_mov_b32 m0, s56
    s_nop 0
    buffer_load_dwordx4 v3, s[4:7], s55 offen lds
    s_add_u32 s57, s99, 0
    s_and_b32 s57, s57, 7
    s_mul_i32 s55, s57, 196608
    s_add_u32 s55, s55, s51
    s_add_u32 s55, s55, 0
    s_add_u32 s56, s53, 122880
    s_mov_b32 m0, s56
    s_nop 0
    buffer_load_dwordx4 v4, s[8:11], s55 offen lds
    s_add_u32 s57, s99, 0
    s_and_b32 s57, s57, 7
    s_mul_i32 s55, s57, 196608
    s_add_u32 s55, s55, s51
    s_add_u32 s55, s55, 1024
    s_add_u32 s56, s53, 16384
    s_mov_b32 m0, s56
    s_nop 0
    buffer_load_dwordx4 v4, s[8:11], s55 offen lds
    s_add_u32 s57, s99, 1
    s_and_b32 s57, s57, 7
    s_lshl_b32 s55, s57, 7
    s_add_u32 s56, s52, 24576
    s_mov_b32 m0, s56
    s_nop 0
    buffer_load_dwordx4 v2, s[4:7], s55 offen lds
    s_add_u32 s57, s99, 1
    s_and_b32 s57, s57, 7
    s_lshl_b32 s55, s57, 7
    s_add_u32 s56, s52, 25600
    s_mov_b32 m0, s56
    s_nop 0
    buffer_load_dwordx4 v3, s[4:7], s55 offen lds
    s_add_u32 s57, s99, 1
    s_and_b32 s57, s57, 7
    s_mul_i32 s55, s57, 196608
    s_add_u32 s55, s55, s51
    s_add_u32 s55, s55, 0
    s_add_u32 s56, s53, 126976
    s_mov_b32 m0, s56
    s_nop 0
    buffer_load_dwordx4 v4, s[8:11], s55 offen lds
    s_add_u32 s57, s99, 1
    s_and_b32 s57, s57, 7
    s_mul_i32 s55, s57, 196608
    s_add_u32 s55, s55, s51
    s_add_u32 s55, s55, 1024
    s_add_u32 s56, s53, 40960
    s_mov_b32 m0, s56
    s_nop 0
    buffer_load_dwordx4 v4, s[8:11], s55 offen lds
    s_add_u32 s57, s99, 2
    s_and_b32 s57, s57, 7
    s_lshl_b32 s55, s57, 7
    s_add_u32 s56, s52, 49152
    s_mov_b32 m0, s56
    s_nop 0
    buffer_load_dwordx4 v2, s[4:7], s55 offen lds
    s_add_u32 s57, s99, 2
    s_and_b32 s57, s57, 7
    s_lshl_b32 s55, s57, 7
    s_add_u32 s56, s52, 50176
    s_mov_b32 m0, s56
    s_nop 0
    buffer_load_dwordx4 v3, s[4:7], s55 offen lds
    s_add_u32 s57, s99, 2
    s_and_b32 s57, s57, 7
    s_mul_i32 s55, s57, 196608
    s_add_u32 s55, s55, s51
    s_add_u32 s55, s55, 0
    s_add_u32 s56, s53, 131072
    s_mov_b32 m0, s56
    s_nop 0
    buffer_load_dwordx4 v4, s[8:11], s55 offen lds
    s_add_u32 s57, s99, 2
    s_and_b32 s57, s57, 7
    s_mul_i32 s55, s57, 196608
    s_add_u32 s55, s55, s51
    s_add_u32 s55, s55, 1024
    s_add_u32 s56, s53, 65536
    s_mov_b32 m0, s56
    s_nop 0
    buffer_load_dwordx4 v4, s[8:11], s55 offen lds
    s_mov_b32 s12, s68
    s_and_b32 s13, s69, 0xffff
    s_mov_b32 s14, 524288
    s_mov_b32 s15, 0x20000
    s_mov_b32 s16, s72
    s_and_b32 s17, s73, 0xffff
    s_mov_b32 s18, 1835008
    s_mov_b32 s19, 0x20000
    s_mov_b32 s20, s76
    s_and_b32 s21, s77, 0xffff
    s_mov_b32 s22, 1835008
    s_mov_b32 s23, 0x20000
    s_mov_b32 s24, s74
    s_and_b32 s25, s75, 0xffff
    s_mov_b32 s26, 3584
    s_mov_b32 s27, 0x20000
    s_mov_b32 s28, s78
    s_and_b32 s29, s79, 0xffff
    s_mov_b32 s30, 1024
    s_mov_b32 s31, 0x20000
    s_mov_b32 s32, s80
    s_and_b32 s33, s81, 0xffff
    s_mov_b32 s34, 2097152
    s_mov_b32 s35, 0x20000
    v_and_b32 v10, 31, v1
    s_lshl_b32 s54, s50, 5
    v_add_u32 v11, s54, v10
    v_lshlrev_b32 v11, 7, v11
    v_bfe_u32 v12, v10, 1, 3
    v_lshrrev_b32 v13, 5, v1
    v_xor_b32 v12, v12, v13
    s_add_u32 s48, s50, 0
    s_and_b32 s48, s48, 3
    s_lshl_b32 s49, s48, 1
    v_xor_b32 v14, s49, v12
    v_lshl_add_u32 v5, v14, 4, v11
    s_lshl_b32 s60, s48, 10
    s_add_u32 s48, s50, 1
    s_and_b32 s48, s48, 3
    s_lshl_b32 s49, s48, 1
    v_xor_b32 v14, s49, v12
    v_lshl_add_u32 v6, v14, 4, v11
    s_lshl_b32 s61, s48, 10
    s_add_u32 s48, s50, 2
    s_and_b32 s48, s48, 3
    s_lshl_b32 s49, s48, 1
    v_xor_b32 v14, s49, v12
    v_lshl_add_u32 v7, v14, 4, v11
    s_lshl_b32 s62, s48, 10
    s_add_u32 s48, s50, 3
    s_and_b32 s48, s48, 3
    s_lshl_b32 s49, s48, 1
    v_xor_b32 v14, s49, v12
    v_lshl_add_u32 v8, v14, 4, v11
    s_lshl_b32 s63, s48, 10
    v_bfe_u32 v10, v1, 2, 2
    v_lshl_add_u32 v10, v13, 3, v10
    v_lshlrev_b32 v10, 6, v10
    v_bfe_u32 v11, v1, 4, 1
    v_lshl_add_u32 v10, v11, 5, v10
    v_and_b32 v11, 3, v1
    v_lshl_add_u32 v9, v11, 3, v10
    v_add_u32 v100, s60, v9
    v_add_u32 v101, s61, v9
    v_add_u32 v102, s62, v9
    v_add_u32 v103, s63, v9
    v_mov_b32 v96, 0
    v_mov_b32 v97, 0
    v_mov_b32 v98, 0
    s_mov_b32 s58, 0x3f803f80
    s_or_b32 s48, s2, s46
    s_cmp_lg_u32 s48, 0
    s_cbranch_scc1 Lnoscan2
    s_waitcnt vmcnt(12)
    s_mov_b32 s48, 0
        Lnl_1:
    s_add_u32 s48, s48, 1
    s_mov_b64 s[56:57], 0
    v_cmp_eq_u32 vcc, s48, v116
    s_or_b64 s[56:57], s[56:57], vcc
    v_cmp_eq_u32 vcc, s48, v117
    s_or_b64 s[56:57], s[56:57], vcc
    v_cmp_eq_u32 vcc, s48, v118
    s_or_b64 s[56:57], s[56:57], vcc
    v_cmp_eq_u32 vcc, s48, v119
    s_or_b64 s[56:57], s[56:57], vcc
    v_cmp_eq_u32 vcc, s48, v120
    s_or_b64 s[56:57], s[56:57], vcc
    v_cmp_eq_u32 vcc, s48, v121
    s_or_b64 s[56:57], s[56:57], vcc
    v_cmp_eq_u32 vcc, s48, v122
    s_or_b64 s[56:57], s[56:57], vcc
    v_cmp_eq_u32 vcc, s48, v123
    s_or_b64 s[56:57], s[56:57], vcc
    v_cmp_eq_u32 vcc, s48, v124
    s_or_b64 s[56:57], s[56:57], vcc
    v_cmp_eq_u32 vcc, s48, v125
    s_or_b64 s[56:57], s[56:57], vcc
    v_cmp_eq_u32 vcc, s48, v126
    s_or_b64 s[56:57], s[56:57], vcc
    v_cmp_eq_u32 vcc, s48, v127
    s_or_b64 s[56:57], s[56:57], vcc
    v_cmp_eq_u32 vcc, s48, v128
    s_or_b64 s[56:57], s[56:57], vcc
    v_cmp_eq_u32 vcc, s48, v129
    s_or_b64 s[56:57], s[56:57], vcc
    v_cmp_eq_u32 vcc, s48, v130
    s_or_b64 s[56:57], s[56:57], vcc
    v_cmp_eq_u32 vcc, s48, v131
    s_or_b64 s[56:57], s[56:57], vcc
    s_cmp_lg_u64 s[56:57], 0
    s_cbranch_scc1 Lnl_1
    v_mov_b32 v116, s48
    v_lshlrev_b32 v117, 2, v1
    s_mov_b64 exec, 0xffff
    buffer_store_dword v116, v117, s[36:39], 0 offen sc1
    s_mov_b64 exec, -1
        Lnoscan2:
    v_mov_b32 v15, 0
    s_waitcnt vmcnt(8)
    s_waitcnt lgkmcnt(0)
    s_barrier
    v_add_u32 v10, 0, v5
    v_add_u32 v104, 0, v100
    v_add_u32 v11, 0, v6
    v_add_u32 v105, 0, v101
    v_add_u32 v12, 0, v7
    v_add_u32 v106, 0, v102
    v_add_u32 v13, 0, v8
    v_add_u32 v107, 0, v103
    ds_read_b128 v[116:119], v10
    ds_read_b64_tr_b16 v[64:65], v104 offset:16384
    ds_read_b64_tr_b16 v[66:67], v104 offset:16640
    ds_read_b128 v[120:123], v11
    ds_read_b64_tr_b16 v[68:69], v105 offset:16384
    ds_read_b64_tr_b16 v[70:71], v105 offset:16640
    s_waitcnt lgkmcnt(3)
    v_mfma_f32_32x32x16_bf16 v[32:47], v[64:67], v[116:119], 0
    ds_read_b128 v[124:127], v12
    ds_read_b64_tr_b16 v[72:73], v106 offset:16384
    ds_read_b64_tr_b16 v[74:75], v106 offset:16640
    s_add_u32 s57, s99, 3
    s_and_b32 s57, s57, 7
    s_lshl_b32 s55, s57, 7
    s_add_u32 s56, s52, 73728
    s_mov_b32 m0, s56
    s_nop 0
    buffer_load_dwordx4 v2, s[4:7], s55 offen lds
    s_add_u32 s57, s99, 3
    s_and_b32 s57, s57, 7
    s_lshl_b32 s55, s57, 7
    s_add_u32 s56, s52, 74752
    s_mov_b32 m0, s56
    s_nop 0
    buffer_load_dwordx4 v3, s[4:7], s55 offen lds
    v_dot2c_f32_bf16 v98, s58, v64
    v_dot2c_f32_bf16 v98, s58, v65
    v_dot2c_f32_bf16 v98, s58, v66
    v_dot2c_f32_bf16 v98, s58, v67
    s_waitcnt lgkmcnt(3)
    v_mfma_f32_32x32x16_bf16 v[32:47], v[68:71], v[120:123], v[32:47]
    ds_read_b128 v[128:131], v13
    ds_read_b64_tr_b16 v[76:77], v107 offset:16384
    ds_read_b64_tr_b16 v[78:79], v107 offset:16640
    s_add_u32 s57, s99, 3
    s_and_b32 s57, s57, 7
    s_mul_i32 s55, s57, 196608
    s_add_u32 s55, s55, s51
    s_add_u32 s55, s55, 0
    s_add_u32 s56, s53, 135168
    s_mov_b32 m0, s56
    s_nop 0
    buffer_load_dwordx4 v4, s[8:11], s55 offen lds
    s_add_u32 s57, s99, 3
    s_and_b32 s57, s57, 7
    s_mul_i32 s55, s57, 196608
    s_add_u32 s55, s55, s51
    s_add_u32 s55, s55, 1024
    s_add_u32 s56, s53, 90112
    s_mov_b32 m0, s56
    s_nop 0
    buffer_load_dwordx4 v4, s[8:11], s55 offen lds
    s_waitcnt vmcnt(8)
    s_barrier
    v_add_u32 v10, 24576, v5
    v_add_u32 v104, 24576, v100
    v_add_u32 v11, 24576, v6
    v_add_u32 v105, 24576, v101
    v_add_u32 v12, 24576, v7
    v_add_u32 v106, 24576, v102
    v_add_u32 v13, 24576, v8
    v_add_u32 v107, 24576, v103
    s_waitcnt lgkmcnt(3)
    v_mfma_f32_32x32x16_bf16 v[32:47], v[72:75], v[124:127], v[32:47]
    ds_read_b128 v[132:135], v10
    ds_read_b64_tr_b16 v[64:65], v104 offset:16384
    ds_read_b64_tr_b16 v[66:67], v104 offset:16640
    s_add_u32 s57, s99, 4
    s_and_b32 s57, s57, 7
    s_lshl_b32 s55, s57, 7
    s_add_u32 s56, s52, 98304
    s_mov_b32 m0, s56
    s_nop 0
    buffer_load_dwordx4 v2, s[4:7], s55 offen lds
    s_add_u32 s57, s99, 4
    s_and_b32 s57, s57, 7
    s_lshl_b32 s55, s57, 7
    s_add_u32 s56, s52, 99328
    s_mov_b32 m0, s56
    s_nop 0
    buffer_load_dwordx4 v3, s[4:7], s55 offen lds
    s_waitcnt lgkmcnt(3)
    v_mfma_f32_32x32x16_bf16 v[32:47], v[76:79], v[128:131], v[32:47]
    ds_read_b128 v[136:139], v11
    ds_read_b64_tr_b16 v[68:69], v105 offset:16384
    ds_read_b64_tr_b16 v[70:71], v105 offset:16640
    s_add_u32 s57, s99, 4
    s_and_b32 s57, s57, 7
    s_mul_i32 s55, s57, 196608
    s_add_u32 s55, s55, s51
    s_add_u32 s55, s55, 0
    s_add_u32 s56, s53, 139264
    s_mov_b32 m0, s56
    s_nop 0
    buffer_load_dwordx4 v4, s[8:11], s55 offen lds
    s_add_u32 s57, s99, 4
    s_and_b32 s57, s57, 7
    s_mul_i32 s55, s57, 196608
    s_add_u32 s55, s55, s51
    s_add_u32 s55, s55, 1024
    s_add_u32 s56, s53, 114688
    s_mov_b32 m0, s56
    s_nop 0
    buffer_load_dwordx4 v4, s[8:11], s55 offen lds
    s_waitcnt lgkmcnt(3)
    v_mfma_f32_32x32x16_bf16 v[32:47], v[64:67], v[132:135], v[32:47]
    ds_read_b128 v[140:143], v12
    ds_read_b64_tr_b16 v[72:73], v106 offset:16384
    ds_read_b64_tr_b16 v[74:75], v106 offset:16640
    v_dot2c_f32_bf16 v98, s58, v64
    v_dot2c_f32_bf16 v98, s58, v65
    v_dot2c_f32_bf16 v98, s58, v66
    v_dot2c_f32_bf16 v98, s58, v67
    s_waitcnt lgkmcnt(3)
    v_mfma_f32_32x32x16_bf16 v[32:47], v[68:71], v[136:139], v[32:47]
    ds_read_b128 v[144:147], v13
    ds_read_b64_tr_b16 v[76:77], v107 offset:16384
    ds_read_b64_tr_b16 v[78:79], v107 offset:16640
    s_waitcnt vmcnt(8)
    s_barrier
    v_add_u32 v10, 49152, v5
    v_add_u32 v104, 49152, v100
    v_add_u32 v11, 49152, v6
    v_add_u32 v105, 49152, v101
    v_add_u32 v12, 49152, v7
    v_add_u32 v106, 49152, v102
    v_add_u32 v13, 49152, v8
    v_add_u32 v107, 49152, v103
    s_waitcnt lgkmcnt(3)
    v_mfma_f32_32x32x16_bf16 v[32:47], v[72:75], v[140:143], v[32:47]
    ds_read_b128 v[148:151], v10
    ds_read_b64_tr_b16 v[64:65], v104 offset:16384
    ds_read_b64_tr_b16 v[66:67], v104 offset:16640
    s_add_u32 s57, s99, 5
    s_and_b32 s57, s57, 7
    s_lshl_b32 s55, s57, 7
    s_add_u32 s56, s52, 0
    s_mov_b32 m0, s56
    s_nop 0
    buffer_load_dwordx4 v2, s[4:7], s55 offen lds
    s_add_u32 s57, s99, 5
    s_and_b32 s57, s57, 7
    s_lshl_b32 s55, s57, 7
    s_add_u32 s56, s52, 1024
    s_mov_b32 m0, s56
    s_nop 0
    buffer_load_dwordx4 v3, s[4:7], s55 offen lds
    s_waitcnt lgkmcnt(3)
    v_mfma_f32_32x32x16_bf16 v[32:47], v[76:79], v[144:147], v[32:47]
    ds_read_b128 v[152:155], v11
    ds_read_b64_tr_b16 v[68:69], v105 offset:16384
    ds_read_b64_tr_b16 v[70:71], v105 offset:16640
    s_add_u32 s57, s99, 5
    s_and_b32 s57, s57, 7
    s_mul_i32 s55, s57, 196608
    s_add_u32 s55, s55, s51
    s_add_u32 s55, s55, 0
    s_add_u32 s56, s53, 143360
    s_mov_b32 m0, s56
    s_nop 0
    buffer_load_dwordx4 v4, s[8:11], s55 offen lds
    s_add_u32 s57, s99, 5
    s_and_b32 s57, s57, 7
    s_mul_i32 s55, s57, 196608
    s_add_u32 s55, s55, s51
    s_add_u32 s55, s55, 1024
    s_add_u32 s56, s53, 16384
    s_mov_b32 m0, s56
    s_nop 0
    buffer_load_dwordx4 v4, s[8:11], s55 offen lds
    s_waitcnt lgkmcnt(3)
    v_mfma_f32_32x32x16_bf16 v[32:47], v[64:67], v[148:151], v[32:47]
    ds_read_b128 v[156:159], v12
    ds_read_b64_tr_b16 v[72:73], v106 offset:16384
    ds_read_b64_tr_b16 v[74:75], v106 offset:16640
    v_dot2c_f32_bf16 v98, s58, v64
    v_dot2c_f32_bf16 v98, s58, v65
    v_dot2c_f32_bf16 v98, s58, v66
    v_dot2c_f32_bf16 v98, s58, v67
    s_waitcnt lgkmcnt(3)
    v_mfma_f32_32x32x16_bf16 v[32:47], v[68:71], v[152:155], v[32:47]
    ds_read_b128 v[160:163], v13
    ds_read_b64_tr_b16 v[76:77], v107 offset:16384
    ds_read_b64_tr_b16 v[78:79], v107 offset:16640
    s_waitcnt vmcnt(8)
    s_barrier
    v_add_u32 v10, 73728, v5
    v_add_u32 v104, 73728, v100
    v_add_u32 v11, 73728, v6
    v_add_u32 v105, 73728, v101
    v_add_u32 v12, 73728, v7
    v_add_u32 v106, 73728, v102
    v_add_u32 v13, 73728, v8
    v_add_u32 v107, 73728, v103
    s_waitcnt lgkmcnt(3)
    v_mfma_f32_32x32x16_bf16 v[32:47], v[72:75], v[156:159], v[32:47]
    ds_read_b128 v[164:167], v10
    ds_read_b64_tr_b16 v[64:65], v104 offset:16384
    ds_read_b64_tr_b16 v[66:67], v104 offset:16640
    s_add_u32 s57, s99, 6
    s_and_b32 s57, s57, 7
    s_lshl_b32 s55, s57, 7
    s_add_u32 s56, s52, 24576
    s_mov_b32 m0, s56
    s_nop 0
    buffer_load_dwordx4 v2, s[4:7], s55 offen lds
    s_add_u32 s57, s99, 6
    s_and_b32 s57, s57, 7
    s_lshl_b32 s55, s57, 7
    s_add_u32 s56, s52, 25600
    s_mov_b32 m0, s56
    s_nop 0
    buffer_load_dwordx4 v3, s[4:7], s55 offen lds
    s_waitcnt lgkmcnt(3)
    v_mfma_f32_32x32x16_bf16 v[32:47], v[76:79], v[160:163], v[32:47]
    ds_read_b128 v[168:171], v11
    ds_read_b64_tr_b16 v[68:69], v105 offset:16384
    ds_read_b64_tr_b16 v[70:71], v105 offset:16640
    s_add_u32 s57, s99, 6
    s_and_b32 s57, s57, 7
    s_mul_i32 s55, s57, 196608
    s_add_u32 s55, s55, s51
    s_add_u32 s55, s55, 0
    s_add_u32 s56, s53, 147456
    s_mov_b32 m0, s56
    s_nop 0
    buffer_load_dwordx4 v4, s[8:11], s55 offen lds
    s_add_u32 s57, s99, 6
    s_and_b32 s57, s57, 7
    s_mul_i32 s55, s57, 196608
    s_add_u32 s55, s55, s51
    s_add_u32 s55, s55, 1024
    s_add_u32 s56, s53, 40960
    s_mov_b32 m0, s56
    s_nop 0
    buffer_load_dwordx4 v4, s[8:11], s55 offen lds
    s_waitcnt lgkmcnt(3)
    v_mfma_f32_32x32x16_bf16 v[32:47], v[64:67], v[164:167], v[32:47]
    ds_read_b128 v[172:175], v12
    ds_read_b64_tr_b16 v[72:73], v106 offset:16384
    ds_read_b64_tr_b16 v[74:75], v106 offset:16640
    v_dot2c_f32_bf16 v98, s58, v64
    v_dot2c_f32_bf16 v98, s58, v65
    v_dot2c_f32_bf16 v98, s58, v66
    v_dot2c_f32_bf16 v98, s58, v67
    s_waitcnt lgkmcnt(3)
    v_mfma_f32_32x32x16_bf16 v[32:47], v[68:71], v[168:171], v[32:47]
    ds_read_b128 v[176:179], v13
    ds_read_b64_tr_b16 v[76:77], v107 offset:16384
    ds_read_b64_tr_b16 v[78:79], v107 offset:16640
    s_waitcnt vmcnt(8)
    s_barrier
    v_add_u32 v10, 98304, v5
    v_add_u32 v104, 98304, v100
    v_add_u32 v11, 98304, v6
    v_add_u32 v105, 98304, v101
    v_add_u32 v12, 98304, v7
    v_add_u32 v106, 98304, v102
    v_add_u32 v13, 98304, v8
    v_add_u32 v107, 98304, v103
    s_waitcnt lgkmcnt(3)
    v_mfma_f32_32x32x16_bf16 v[32:47], v[72:75], v[172:175], v[32:47]
    ds_read_b128 v[180:183], v10
    ds_read_b64_tr_b16 v[64:65], v104 offset:16384
    ds_read_b64_tr_b16 v[66:67], v104 offset:16640
    s_add_u32 s57, s99, 7
    s_and_b32 s57, s57, 7
    s_lshl_b32 s55, s57, 7
    s_add_u32 s56, s52, 49152
    s_mov_b32 m0, s56
    s_nop 0
    buffer_load_dwordx4 v2, s[4:7], s55 offen lds
    s_add_u32 s57, s99, 7
    s_and_b32 s57, s57, 7
    s_lshl_b32 s55, s57, 7
    s_add_u32 s56, s52, 50176
    s_mov_b32 m0, s56
    s_nop 0
    buffer_load_dwordx4 v3, s[4:7], s55 offen lds
    s_waitcnt lgkmcnt(3)
    v_mfma_f32_32x32x16_bf16 v[32:47], v[76:79], v[176:179], v[32:47]
    ds_read_b128 v[184:187], v11
    ds_read_b64_tr_b16 v[68:69], v105 offset:16384
    ds_read_b64_tr_b16 v[70:71], v105 offset:16640
    s_add_u32 s57, s99, 7
    s_and_b32 s57, s57, 7
    s_mul_i32 s55, s57, 196608
    s_add_u32 s55, s55, s51
    s_add_u32 s55, s55, 0
    s_add_u32 s56, s53, 151552
    s_mov_b32 m0, s56
    s_nop 0
    buffer_load_dwordx4 v4, s[8:11], s55 offen lds
    s_add_u32 s57, s99, 7
    s_and_b32 s57, s57, 7
    s_mul_i32 s55, s57, 196608
    s_add_u32 s55, s55, s51
    s_add_u32 s55, s55, 1024
    s_add_u32 s56, s53, 65536
    s_mov_b32 m0, s56
    s_nop 0
    buffer_load_dwordx4 v4, s[8:11], s55 offen lds
    s_waitcnt lgkmcnt(3)
    v_mfma_f32_32x32x16_bf16 v[32:47], v[64:67], v[180:183], v[32:47]
    ds_read_b128 v[188:191], v12
    ds_read_b64_tr_b16 v[72:73], v106 offset:16384
    ds_read_b64_tr_b16 v[74:75], v106 offset:16640
    v_dot2c_f32_bf16 v98, s58, v64
    v_dot2c_f32_bf16 v98, s58, v65
    v_dot2c_f32_bf16 v98, s58, v66
    v_dot2c_f32_bf16 v98, s58, v67
    s_waitcnt lgkmcnt(3)
    v_mfma_f32_32x32x16_bf16 v[32:47], v[68:71], v[184:187], v[32:47]
    ds_read_b128 v[192:195], v13
    ds_read_b64_tr_b16 v[76:77], v107 offset:16384
    ds_read_b64_tr_b16 v[78:79], v107 offset:16640
    s_waitcnt vmcnt(8)
    s_barrier
    v_add_u32 v10, 0, v5
    v_add_u32 v104, 0, v100
    v_add_u32 v11, 0, v6
    v_add_u32 v105, 0, v101
    v_add_u32 v12, 0, v7
    v_add_u32 v106, 0, v102
    v_add_u32 v13, 0, v8
    v_add_u32 v107, 0, v103
    s_waitcnt lgkmcnt(3)
    v_mfma_f32_32x32x16_bf16 v[32:47], v[72:75], v[188:191], v[32:47]
    ds_read_b128 v[196:199], v10
    ds_read_b64_tr_b16 v[64:65], v104 offset:16384
    ds_read_b64_tr_b16 v[66:67], v104 offset:16640
    s_waitcnt lgkmcnt(3)
    v_mfma_f32_32x32x16_bf16 v[32:47], v[76:79], v[192:195], v[32:47]
    ds_read_b128 v[200:203], v11
    ds_read_b64_tr_b16 v[68:69], v105 offset:16384
    ds_read_b64_tr_b16 v[70:71], v105 offset:16640
    s_waitcnt lgkmcnt(3)
    v_mfma_f32_32x32x16_bf16 v[32:47], v[64:67], v[196:199], v[32:47]
    ds_read_b128 v[204:207], v12
    ds_read_b64_tr_b16 v[72:73], v106 offset:16384
    ds_read_b64_tr_b16 v[74:75], v106 offset:16640
    v_dot2c_f32_bf16 v98, s58, v64
    v_dot2c_f32_bf16 v98, s58, v65
    v_dot2c_f32_bf16 v98, s58, v66
    v_dot2c_f32_bf16 v98, s58, v67
    s_waitcnt lgkmcnt(3)
    v_mfma_f32_32x32x16_bf16 v[32:47], v[68:71], v[200:203], v[32:47]
    ds_read_b128 v[208:211], v13
    ds_read_b64_tr_b16 v[76:77], v107 offset:16384
    ds_read_b64_tr_b16 v[78:79], v107 offset:16640
    s_waitcnt vmcnt(4)
    s_barrier
    v_add_u32 v10, 24576, v5
    v_add_u32 v104, 24576, v100
    v_add_u32 v11, 24576, v6
    v_add_u32 v105, 24576, v101
    v_add_u32 v12, 24576, v7
    v_add_u32 v106, 24576, v102
    v_add_u32 v13, 24576, v8
    v_add_u32 v107, 24576, v103
    s_waitcnt lgkmcnt(3)
    v_mfma_f32_32x32x16_bf16 v[32:47], v[72:75], v[204:207], v[32:47]
    ds_read_b128 v[212:215], v10
    ds_read_b64_tr_b16 v[64:65], v104 offset:16384
    ds_read_b64_tr_b16 v[66:67], v104 offset:16640
    s_lshr_b32 s48, s2, 3
    s_lshl_b32 s48, s48, 3
    s_add_u32 s48, s48, s46
    s_and_b32 s49, s2, 1
    s_cmp_lt_u32 s48, 32
    s_cbranch_scc1 Lta_2
    s_cmp_ge_u32 s48, 144
    s_cbranch_scc1 Ltb_3
    s_sub_u32 s48, s48, 32
    s_lshl_b32 s48, s48, 6
    v_add_u32 v250, s48, v1
    v_mul_u32_u24 v251, 74899, v250
    v_lshrrev_b32 v251, 20, v251
    v_mul_u32_u24 v251, 1792, v251
    v_lshl_add_u32 v250, v250, 7, v251
    s_mul_i32 s49, s49, 1792
    buffer_load_dword v246, v250, s[16:19], s49 offen
    s_branch Ltd_4
Lta_2:
    s_sub_u32 s48, s48, 0
    s_lshl_b32 s48, s48, 14
    s_lshl_b32 s49, s49, 9
    s_add_u32 s48, s48, s49
    v_lshrrev_b32 v250, 2, v1
    v_and_b32 v251, 3, v1
    v_lshlrev_b32 v251, 7, v251
    v_lshl_add_u32 v250, v250, 10, v251
    buffer_load_dword v246, v250, s[12:15], s48 offen
    s_branch Ltd_4
Ltb_3:
    s_sub_u32 s48, s48, 144
    s_lshl_b32 s48, s48, 14
    s_lshl_b32 s49, s49, 9
    s_add_u32 s48, s48, s49
    v_lshrrev_b32 v250, 2, v1
    v_and_b32 v251, 3, v1
    v_lshlrev_b32 v251, 7, v251
    v_lshl_add_u32 v250, v250, 10, v251
    buffer_load_dword v246, v250, s[20:23], s48 offen
Ltd_4:
    s_waitcnt lgkmcnt(3)
    v_mfma_f32_32x32x16_bf16 v[32:47], v[76:79], v[208:211], v[32:47]
    ds_read_b128 v[216:219], v11
    ds_read_b64_tr_b16 v[68:69], v105 offset:16384
    ds_read_b64_tr_b16 v[70:71], v105 offset:16640
    s_waitcnt lgkmcnt(3)
    v_mfma_f32_32x32x16_bf16 v[32:47], v[64:67], v[212:215], v[32:47]
    ds_read_b128 v[220:223], v12
    ds_read_b64_tr_b16 v[72:73], v106 offset:16384
    ds_read_b64_tr_b16 v[74:75], v106 offset:16640
    v_dot2c_f32_bf16 v98, s58, v64
    v_dot2c_f32_bf16 v98, s58, v65
    v_dot2c_f32_bf16 v98, s58, v66
    v_dot2c_f32_bf16 v98, s58, v67
    s_waitcnt lgkmcnt(3)
    v_mfma_f32_32x32x16_bf16 v[32:47], v[68:71], v[216:219], v[32:47]
    ds_read_b128 v[224:227], v13
    ds_read_b64_tr_b16 v[76:77], v107 offset:16384
    ds_read_b64_tr_b16 v[78:79], v107 offset:16640
    s_waitcnt vmcnt(1)
    s_barrier
    v_add_u32 v10, 49152, v5
    v_add_u32 v104, 49152, v100
    v_add_u32 v11, 49152, v6
    v_add_u32 v105, 49152, v101
    v_add_u32 v12, 49152, v7
    v_add_u32 v106, 49152, v102
    v_add_u32 v13, 49152, v8
    v_add_u32 v107, 49152, v103
    s_waitcnt lgkmcnt(3)
    v_mfma_f32_32x32x16_bf16 v[32:47], v[72:75], v[220:223], v[32:47]
    ds_read_b128 v[228:231], v10
    ds_read_b64_tr_b16 v[64:65], v104 offset:16384
    ds_read_b64_tr_b16 v[66:67], v104 offset:16640
    s_waitcnt lgkmcnt(3)
    v_mfma_f32_32x32x16_bf16 v[32:47], v[76:79], v[224:227], v[32:47]
    ds_read_b128 v[232:235], v11
    ds_read_b64_tr_b16 v[68:69], v105 offset:16384
    ds_read_b64_tr_b16 v[70:71], v105 offset:16640
    s_waitcnt lgkmcnt(3)
    v_mfma_f32_32x32x16_bf16 v[32:47], v[64:67], v[228:231], v[32:47]
    ds_read_b128 v[236:239], v12
    ds_read_b64_tr_b16 v[72:73], v106 offset:16384
    ds_read_b64_tr_b16 v[74:75], v106 offset:16640
    v_dot2c_f32_bf16 v98, s58, v64
    v_dot2c_f32_bf16 v98, s58, v65
    v_dot2c_f32_bf16 v98, s58, v66
    v_dot2c_f32_bf16 v98, s58, v67
    s_waitcnt lgkmcnt(3)
    v_mfma_f32_32x32x16_bf16 v[32:47], v[68:71], v[232:235], v[32:47]
    ds_read_b128 v[240:243], v13
    ds_read_b64_tr_b16 v[76:77], v107 offset:16384
    ds_read_b64_tr_b16 v[78:79], v107 offset:16640
    s_waitcnt lgkmcnt(3)
    v_mfma_f32_32x32x16_bf16 v[32:47], v[72:75], v[236:239], v[32:47]
    s_waitcnt lgkmcnt(0)
    v_mfma_f32_32x32x16_bf16 v[32:47], v[76:79], v[240:243], v[32:47]
    s_nop 7
    v_and_b32 v10, 31, v1
    v_lshlrev_b32 v11, 2, v10
    v_add_u32 v11, 156672, v11
    ds_add_f32 v11, v98 offset:128
    v_mov_b32 v251, 0
    buffer_load_dword v249, v251, s[36:39], 0 offen sc1
    s_waitcnt lgkmcnt(0)
    s_barrier
    v_lshrrev_b32 v13, 5, v1
    v_lshlrev_b32 v15, 4, v1
    s_lshl_b32 s55, s44, 4
    s_add_u32 s55, s55, s45
    s_lshl_b32 s55, s55, 14
    s_lshl_b32 s56, s50, 11
    s_add_u32 s55, s55, s56
    s_add_u32 s55, s55, 65536
    v_add_u32 v11, s54, v10
    v_lshlrev_b32 v11, 2, v11
    v_add_u32 v11, 155648, v11
    v_lshlrev_b32 v12, 4, v13
    v_add_u32 v12, 156672, v12
    ds_read_b32 v96, v11
    ds_read_b32 v97, v11 offset:512
    ds_read_b128 v[64:67], v12 offset:128
    ds_read_b128 v[68:71], v12 offset:160
    ds_read_b128 v[72:75], v12 offset:192
    ds_read_b128 v[76:79], v12 offset:224
    v_add_u32 v14, s56, v15
    s_waitcnt lgkmcnt(4)
    v_mul_f32 v98, 0x3eb8aa3b, v96
    v_mul_f32 v99, 0x3eb8aa3b, v97
    s_waitcnt lgkmcnt(0)
    v_mul_f32 v64, v97, v64
    v_fma_f32 v32, v32, v96, v64
    v_mul_f32 v65, v97, v65
    v_fma_f32 v33, v33, v96, v65
    v_mul_f32 v66, v97, v66
    v_fma_f32 v34, v34, v96, v66
    v_mul_f32 v67, v97, v67
    v_fma_f32 v35, v35, v96, v67
    v_mul_f32 v68, v97, v68
    v_fma_f32 v36, v36, v96, v68
    v_mul_f32 v69, v97, v69
    v_fma_f32 v37, v37, v96, v69
    v_mul_f32 v70, v97, v70
    v_fma_f32 v38, v38, v96, v70
    v_mul_f32 v71, v97, v71
    v_fma_f32 v39, v39, v96, v71
    v_mul_f32 v72, v97, v72
    v_fma_f32 v40, v40, v96, v72
    v_mul_f32 v73, v97, v73
    v_fma_f32 v41, v41, v96, v73
    v_mul_f32 v74, v97, v74
    v_fma_f32 v42, v42, v96, v74
    v_mul_f32 v75, v97, v75
    v_fma_f32 v43, v43, v96, v75
    v_mul_f32 v76, v97, v76
    v_fma_f32 v44, v44, v96, v76
    v_mul_f32 v77, v97, v77
    v_fma_f32 v45, v45, v96, v77
    v_mul_f32 v78, v97, v78
    v_fma_f32 v46, v46, v96, v78
    v_mul_f32 v79, v97, v79
    v_fma_f32 v47, v47, v96, v79
    v_cvt_pk_bf16_f32 v80, v32, v33
    v_cvt_pk_bf16_f32 v81, v34, v35
    v_cvt_pk_bf16_f32 v82, v36, v37
    v_cvt_pk_bf16_f32 v83, v38, v39
    v_cvt_pk_bf16_f32 v84, v40, v41
    v_cvt_pk_bf16_f32 v85, v42, v43
    v_cvt_pk_bf16_f32 v86, v44, v45
    v_cvt_pk_bf16_f32 v87, v46, v47
    buffer_store_dwordx4 v[80:83], v15, s[40:43], s55 offen offset:0 sc1
    ds_write_b128 v14, v[80:83] offset:16384
    buffer_store_dwordx4 v[84:87], v15, s[40:43], s55 offen offset:1024 sc1
    ds_write_b128 v14, v[84:87] offset:17408
    v_add_u32 v104, 122880, v100
    v_add_u32 v105, 122880, v101
    v_add_u32 v106, 122880, v102
    v_add_u32 v107, 122880, v103
    ds_read_b64_tr_b16 v[48:49], v104 offset:0
    ds_read_b64_tr_b16 v[50:51], v104 offset:256
    ds_read_b64_tr_b16 v[52:53], v105 offset:0
    ds_read_b64_tr_b16 v[54:55], v105 offset:256
    ds_read_b64_tr_b16 v[56:57], v106 offset:0
    ds_read_b64_tr_b16 v[58:59], v106 offset:256
    s_waitcnt lgkmcnt(4)
    v_mfma_f32_32x32x16_bf16 v[16:31], v[48:51], v[116:119], 0
    ds_read_b64_tr_b16 v[60:61], v107 offset:0
    ds_read_b64_tr_b16 v[62:63], v107 offset:256
    s_waitcnt lgkmcnt(4)
    v_mfma_f32_32x32x16_bf16 v[16:31], v[52:55], v[120:123], v[16:31]
    ds_read_b64_tr_b16 v[48:49], v104 offset:4096
    ds_read_b64_tr_b16 v[50:51], v104 offset:4352
    s_waitcnt lgkmcnt(4)
    v_mfma_f32_32x32x16_bf16 v[16:31], v[56:59], v[124:127], v[16:31]
    ds_read_b64_tr_b16 v[52:53], v105 offset:4096
    ds_read_b64_tr_b16 v[54:55], v105 offset:4352
    s_waitcnt lgkmcnt(4)
    v_mfma_f32_32x32x16_bf16 v[16:31], v[60:63], v[128:131], v[16:31]
    ds_read_b64_tr_b16 v[56:57], v106 offset:4096
    ds_read_b64_tr_b16 v[58:59], v106 offset:4352
    s_waitcnt lgkmcnt(4)
    v_mfma_f32_32x32x16_bf16 v[16:31], v[48:51], v[132:135], v[16:31]
    ds_read_b64_tr_b16 v[60:61], v107 offset:4096
    ds_read_b64_tr_b16 v[62:63], v107 offset:4352
    s_waitcnt lgkmcnt(4)
    v_mfma_f32_32x32x16_bf16 v[16:31], v[52:55], v[136:139], v[16:31]
    ds_read_b64_tr_b16 v[48:49], v104 offset:8192
    ds_read_b64_tr_b16 v[50:51], v104 offset:8448
    s_waitcnt lgkmcnt(4)
    v_mfma_f32_32x32x16_bf16 v[16:31], v[56:59], v[140:143], v[16:31]
    ds_read_b64_tr_b16 v[52:53], v105 offset:8192
    ds_read_b64_tr_b16 v[54:55], v105 offset:8448
    s_waitcnt lgkmcnt(4)
    v_mfma_f32_32x32x16_bf16 v[16:31], v[60:63], v[144:147], v[16:31]
    ds_read_b64_tr_b16 v[56:57], v106 offset:8192
    ds_read_b64_tr_b16 v[58:59], v106 offset:8448
    s_waitcnt lgkmcnt(4)
    v_mfma_f32_32x32x16_bf16 v[16:31], v[48:51], v[148:151], v[16:31]
    ds_read_b64_tr_b16 v[60:61], v107 offset:8192
    ds_read_b64_tr_b16 v[62:63], v107 offset:8448
    s_waitcnt lgkmcnt(4)
    v_mfma_f32_32x32x16_bf16 v[16:31], v[52:55], v[152:155], v[16:31]
    ds_read_b64_tr_b16 v[48:49], v104 offset:12288
    ds_read_b64_tr_b16 v[50:51], v104 offset:12544
    s_waitcnt lgkmcnt(4)
    v_mfma_f32_32x32x16_bf16 v[16:31], v[56:59], v[156:159], v[16:31]
    ds_read_b64_tr_b16 v[52:53], v105 offset:12288
    ds_read_b64_tr_b16 v[54:55], v105 offset:12544
    s_waitcnt lgkmcnt(4)
    v_mfma_f32_32x32x16_bf16 v[16:31], v[60:63], v[160:163], v[16:31]
    ds_read_b64_tr_b16 v[56:57], v106 offset:12288
    ds_read_b64_tr_b16 v[58:59], v106 offset:12544
    s_waitcnt lgkmcnt(4)
    v_mfma_f32_32x32x16_bf16 v[16:31], v[48:51], v[164:167], v[16:31]
    ds_read_b64_tr_b16 v[60:61], v107 offset:12288
    ds_read_b64_tr_b16 v[62:63], v107 offset:12544
    s_waitcnt lgkmcnt(4)
    v_mfma_f32_32x32x16_bf16 v[16:31], v[52:55], v[168:171], v[16:31]
    ds_read_b64_tr_b16 v[48:49], v104 offset:16384
    ds_read_b64_tr_b16 v[50:51], v104 offset:16640
    s_waitcnt lgkmcnt(4)
    v_mfma_f32_32x32x16_bf16 v[16:31], v[56:59], v[172:175], v[16:31]
    ds_read_b64_tr_b16 v[52:53], v105 offset:16384
    ds_read_b64_tr_b16 v[54:55], v105 offset:16640
    s_waitcnt lgkmcnt(4)
    v_mfma_f32_32x32x16_bf16 v[16:31], v[60:63], v[176:179], v[16:31]
    ds_read_b64_tr_b16 v[56:57], v106 offset:16384
    ds_read_b64_tr_b16 v[58:59], v106 offset:16640
    s_waitcnt lgkmcnt(4)
    v_mfma_f32_32x32x16_bf16 v[16:31], v[48:51], v[180:183], v[16:31]
    ds_read_b64_tr_b16 v[60:61], v107 offset:16384
    ds_read_b64_tr_b16 v[62:63], v107 offset:16640
    s_waitcnt lgkmcnt(4)
    v_mfma_f32_32x32x16_bf16 v[16:31], v[52:55], v[184:187], v[16:31]
    ds_read_b64_tr_b16 v[48:49], v104 offset:20480
    ds_read_b64_tr_b16 v[50:51], v104 offset:20736
    s_waitcnt lgkmcnt(4)
    v_mfma_f32_32x32x16_bf16 v[16:31], v[56:59], v[188:191], v[16:31]
    ds_read_b64_tr_b16 v[52:53], v105 offset:20480
    ds_read_b64_tr_b16 v[54:55], v105 offset:20736
    s_waitcnt lgkmcnt(4)
    v_mfma_f32_32x32x16_bf16 v[16:31], v[60:63], v[192:195], v[16:31]
    ds_read_b64_tr_b16 v[56:57], v106 offset:20480
    ds_read_b64_tr_b16 v[58:59], v106 offset:20736
    s_waitcnt lgkmcnt(4)
    v_mfma_f32_32x32x16_bf16 v[16:31], v[48:51], v[196:199], v[16:31]
    ds_read_b64_tr_b16 v[60:61], v107 offset:20480
    ds_read_b64_tr_b16 v[62:63], v107 offset:20736
    s_waitcnt lgkmcnt(4)
    v_mfma_f32_32x32x16_bf16 v[16:31], v[52:55], v[200:203], v[16:31]
    ds_read_b64_tr_b16 v[48:49], v104 offset:24576
    ds_read_b64_tr_b16 v[50:51], v104 offset:24832
    s_waitcnt lgkmcnt(4)
    v_mfma_f32_32x32x16_bf16 v[16:31], v[56:59], v[204:207], v[16:31]
    ds_read_b64_tr_b16 v[52:53], v105 offset:24576
    ds_read_b64_tr_b16 v[54:55], v105 offset:24832
    s_waitcnt lgkmcnt(4)
    v_mfma_f32_32x32x16_bf16 v[16:31], v[60:63], v[208:211], v[16:31]
    ds_read_b64_tr_b16 v[56:57], v106 offset:24576
    ds_read_b64_tr_b16 v[58:59], v106 offset:24832
    s_waitcnt lgkmcnt(4)
    v_mfma_f32_32x32x16_bf16 v[16:31], v[48:51], v[212:215], v[16:31]
    ds_read_b64_tr_b16 v[60:61], v107 offset:24576
    ds_read_b64_tr_b16 v[62:63], v107 offset:24832
    s_waitcnt lgkmcnt(4)
    v_mfma_f32_32x32x16_bf16 v[16:31], v[52:55], v[216:219], v[16:31]
    ds_read_b64_tr_b16 v[48:49], v104 offset:28672
    ds_read_b64_tr_b16 v[50:51], v104 offset:28928
    s_waitcnt lgkmcnt(4)
    v_mfma_f32_32x32x16_bf16 v[16:31], v[56:59], v[220:223], v[16:31]
    ds_read_b64_tr_b16 v[52:53], v105 offset:28672
    ds_read_b64_tr_b16 v[54:55], v105 offset:28928
    s_waitcnt lgkmcnt(4)
    v_mfma_f32_32x32x16_bf16 v[16:31], v[60:63], v[224:227], v[16:31]
    ds_read_b64_tr_b16 v[56:57], v106 offset:28672
    ds_read_b64_tr_b16 v[58:59], v106 offset:28928
    s_waitcnt lgkmcnt(4)
    v_mfma_f32_32x32x16_bf16 v[16:31], v[48:51], v[228:231], v[16:31]
    ds_read_b64_tr_b16 v[60:61], v107 offset:28672
    ds_read_b64_tr_b16 v[62:63], v107 offset:28928
    s_waitcnt lgkmcnt(4)
    v_mfma_f32_32x32x16_bf16 v[16:31], v[52:55], v[232:235], v[16:31]
    s_waitcnt lgkmcnt(2)
    v_mfma_f32_32x32x16_bf16 v[16:31], v[56:59], v[236:239], v[16:31]
    s_waitcnt lgkmcnt(0)
    v_mfma_f32_32x32x16_bf16 v[16:31], v[60:63], v[240:243], v[16:31]
    s_branch Lp1done
Lrole1:
    s_add_u32 s57, s99, 0
    s_and_b32 s57, s57, 7
    s_lshl_b32 s55, s57, 7
    s_add_u32 s56, s52, 0
    s_mov_b32 m0, s56
    s_nop 0
    buffer_load_dwordx4 v2, s[4:7], s55 offen lds
    s_add_u32 s57, s99, 0
    s_and_b32 s57, s57, 7
    s_lshl_b32 s55, s57, 7
    s_add_u32 s56, s52, 1024
    s_mov_b32 m0, s56
    s_nop 0
    buffer_load_dwordx4 v3, s[4:7], s55 offen lds
    s_add_u32 s57, s99, 0
    s_and_b32 s57, s57, 7
    s_mul_i32 s55, s57, 196608
    s_add_u32 s55, s55, s51
    s_add_u32 s55, s55, 2048
    s_add_u32 s56, s53, 20480
    s_mov_b32 m0, s56
    s_nop 0
    buffer_load_dwordx4 v4, s[8:11], s55 offen lds
    s_add_u32 s57, s99, 1
    s_and_b32 s57, s57, 7
    s_lshl_b32 s55, s57, 7
    s_add_u32 s56, s52, 24576
    s_mov_b32 m0, s56
    s_nop 0
    buffer_load_dwordx4 v2, s[4:7], s55 offen lds
    s_add_u32 s57, s99, 1
    s_and_b32 s57, s57, 7
    s_lshl_b32 s55, s57, 7
    s_add_u32 s56, s52, 25600
    s_mov_b32 m0, s56
    s_nop 0
    buffer_load_dwordx4 v3, s[4:7], s55 offen lds
    s_add_u32 s57, s99, 1
    s_and_b32 s57, s57, 7
    s_mul_i32 s55, s57, 196608
    s_add_u32 s55, s55, s51
    s_add_u32 s55, s55, 2048
    s_add_u32 s56, s53, 45056
    s_mov_b32 m0, s56
    s_nop 0
    buffer_load_dwordx4 v4, s[8:11], s55 offen lds
    s_add_u32 s57, s99, 2
    s_and_b32 s57, s57, 7
    s_lshl_b32 s55, s57, 7
    s_add_u32 s56, s52, 49152
    s_mov_b32 m0, s56
    s_nop 0
    buffer_load_dwordx4 v2, s[4:7], s55 offen lds
    s_add_u32 s57, s99, 2
    s_and_b32 s57, s57, 7
    s_lshl_b32 s55, s57, 7
    s_add_u32 s56, s52, 50176
    s_mov_b32 m0, s56
    s_nop 0
    buffer_load_dwordx4 v3, s[4:7], s55 offen lds
    s_add_u32 s57, s99, 2
    s_and_b32 s57, s57, 7
    s_mul_i32 s55, s57, 196608
    s_add_u32 s55, s55, s51
    s_add_u32 s55, s55, 2048
    s_add_u32 s56, s53, 69632
    s_mov_b32 m0, s56
    s_nop 0
    buffer_load_dwordx4 v4, s[8:11], s55 offen lds
    s_mov_b32 s12, s68
    s_and_b32 s13, s69, 0xffff
    s_mov_b32 s14, 524288
    s_mov_b32 s15, 0x20000
    s_mov_b32 s16, s72
    s_and_b32 s17, s73, 0xffff
    s_mov_b32 s18, 1835008
    s_mov_b32 s19, 0x20000
    s_mov_b32 s20, s76
    s_and_b32 s21, s77, 0xffff
    s_mov_b32 s22, 1835008
    s_mov_b32 s23, 0x20000
    s_mov_b32 s24, s74
    s_and_b32 s25, s75, 0xffff
    s_mov_b32 s26, 3584
    s_mov_b32 s27, 0x20000
    s_mov_b32 s28, s78
    s_and_b32 s29, s79, 0xffff
    s_mov_b32 s30, 1024
    s_mov_b32 s31, 0x20000
    s_mov_b32 s32, s80
    s_and_b32 s33, s81, 0xffff
    s_mov_b32 s34, 2097152
    s_mov_b32 s35, 0x20000
    v_and_b32 v10, 31, v1
    s_lshl_b32 s54, s50, 5
    v_add_u32 v11, s54, v10
    v_lshlrev_b32 v11, 7, v11
    v_bfe_u32 v12, v10, 1, 3
    v_lshrrev_b32 v13, 5, v1
    v_xor_b32 v12, v12, v13
    s_add_u32 s48, s50, 0
    s_and_b32 s48, s48, 3
    s_lshl_b32 s49, s48, 1
    v_xor_b32 v14, s49, v12
    v_lshl_add_u32 v5, v14, 4, v11
    s_lshl_b32 s60, s48, 10
    s_add_u32 s48, s50, 1
    s_and_b32 s48, s48, 3
    s_lshl_b32 s49, s48, 1
    v_xor_b32 v14, s49, v12
    v_lshl_add_u32 v6, v14, 4, v11
    s_lshl_b32 s61, s48, 10
    s_add_u32 s48, s50, 2
    s_and_b32 s48, s48, 3
    s_lshl_b32 s49, s48, 1
    v_xor_b32 v14, s49, v12
    v_lshl_add_u32 v7, v14, 4, v11
    s_lshl_b32 s62, s48, 10
    s_add_u32 s48, s50, 3
    s_and_b32 s48, s48, 3
    s_lshl_b32 s49, s48, 1
    v_xor_b32 v14, s49, v12
    v_lshl_add_u32 v8, v14, 4, v11
    s_lshl_b32 s63, s48, 10
    v_bfe_u32 v10, v1, 2, 2
    v_lshl_add_u32 v10, v13, 3, v10
    v_lshlrev_b32 v10, 6, v10
    v_bfe_u32 v11, v1, 4, 1
    v_lshl_add_u32 v10, v11, 5, v10
    v_and_b32 v11, 3, v1
    v_lshl_add_u32 v9, v11, 3, v10
    v_add_u32 v100, s60, v9
    v_add_u32 v101, s61, v9
    v_add_u32 v102, s62, v9
    v_add_u32 v103, s63, v9
    v_mov_b32 v96, 0
    v_mov_b32 v97, 0
    v_mov_b32 v98, 0
    s_mov_b32 s58, 0x3f803f80
    v_lshlrev_b32 v11, 2, v1
    v_add_u32 v11, 156672, v11
    ds_write_b32 v11, v96
    ds_write_b32 v11, v96 offset:256
    v_mov_b32 v112, s58
    v_mov_b32 v113, s58
    v_mov_b32 v114, s58
    v_mov_b32 v115, s58
    v_mov_b32 v15, 0
    s_waitcnt vmcnt(6)
    s_waitcnt lgkmcnt(0)
    s_barrier
    v_add_u32 v10, 0, v5
    v_add_u32 v104, 0, v100
    v_add_u32 v11, 0, v6
    v_add_u32 v105, 0, v101
    v_add_u32 v12, 0, v7
    v_add_u32 v106, 0, v102
    v_add_u32 v13, 0, v8
    v_add_u32 v107, 0, v103
    ds_read_b128 v[48:51], v10
    ds_read_b64_tr_b16 v[64:65], v104 offset:20480
    ds_read_b64_tr_b16 v[66:67], v104 offset:20736
    ds_read_b128 v[52:55], v11
    ds_read_b64_tr_b16 v[68:69], v105 offset:20480
    ds_read_b64_tr_b16 v[70:71], v105 offset:20736
    s_waitcnt lgkmcnt(3)
    v_mfma_f32_32x32x16_bf16 v[16:31], v[48:51], v[64:67], 0
    ds_read_b128 v[56:59], v12
    v_mfma_f32_32x32x16_bf16 v[32:47], v[48:51], v[48:51], 0
    ds_read_b64_tr_b16 v[72:73], v106 offset:20480
    ds_read_b64_tr_b16 v[74:75], v106 offset:20736
    v_mfma_f32_32x32x16_bf16 v[116:131], v[112:115], v[48:51], 0
    s_add_u32 s57, s99, 3
    s_and_b32 s57, s57, 7
    s_lshl_b32 s55, s57, 7
    s_add_u32 s56, s52, 73728
    s_mov_b32 m0, s56
    s_nop 0
    buffer_load_dwordx4 v2, s[4:7], s55 offen lds
    s_add_u32 s57, s99, 3
    s_and_b32 s57, s57, 7
    s_lshl_b32 s55, s57, 7
    s_add_u32 s56, s52, 74752
    s_mov_b32 m0, s56
    s_nop 0
    buffer_load_dwordx4 v3, s[4:7], s55 offen lds
    v_dot2c_f32_bf16 v98, s58, v64
    v_dot2c_f32_bf16 v98, s58, v65
    v_dot2c_f32_bf16 v98, s58, v66
    v_dot2c_f32_bf16 v98, s58, v67
    s_waitcnt lgkmcnt(3)
    v_mfma_f32_32x32x16_bf16 v[16:31], v[52:55], v[68:71], v[16:31]
    ds_read_b128 v[60:63], v13
    v_mfma_f32_32x32x16_bf16 v[32:47], v[52:55], v[52:55], v[32:47]
    ds_read_b64_tr_b16 v[76:77], v107 offset:20480
    ds_read_b64_tr_b16 v[78:79], v107 offset:20736
    v_mfma_f32_32x32x16_bf16 v[116:131], v[112:115], v[52:55], v[116:131]
    s_add_u32 s57, s99, 3
    s_and_b32 s57, s57, 7
    s_mul_i32 s55, s57, 196608
    s_add_u32 s55, s55, s51
    s_add_u32 s55, s55, 2048
    s_add_u32 s56, s53, 94208
    s_mov_b32 m0, s56
    s_nop 0
    buffer_load_dwordx4 v4, s[8:11], s55 offen lds
    s_waitcnt vmcnt(6)
    s_barrier
    v_add_u32 v10, 24576, v5
    v_add_u32 v104, 24576, v100
    v_add_u32 v11, 24576, v6
    v_add_u32 v105, 24576, v101
    v_add_u32 v12, 24576, v7
    v_add_u32 v106, 24576, v102
    v_add_u32 v13, 24576, v8
    v_add_u32 v107, 24576, v103
    s_waitcnt lgkmcnt(3)
    v_mfma_f32_32x32x16_bf16 v[16:31], v[56:59], v[72:75], v[16:31]
    ds_read_b128 v[48:51], v10
    v_mfma_f32_32x32x16_bf16 v[32:47], v[56:59], v[56:59], v[32:47]
    ds_read_b64_tr_b16 v[64:65], v104 offset:20480
    ds_read_b64_tr_b16 v[66:67], v104 offset:20736
    v_mfma_f32_32x32x16_bf16 v[116:131], v[112:115], v[56:59], v[116:131]
    s_add_u32 s57, s99, 4
    s_and_b32 s57, s57, 7
    s_lshl_b32 s55, s57, 7
    s_add_u32 s56, s52, 98304
    s_mov_b32 m0, s56
    s_nop 0
    buffer_load_dwordx4 v2, s[4:7], s55 offen lds
    s_add_u32 s57, s99, 4
    s_and_b32 s57, s57, 7
    s_lshl_b32 s55, s57, 7
    s_add_u32 s56, s52, 99328
    s_mov_b32 m0, s56
    s_nop 0
    buffer_load_dwordx4 v3, s[4:7], s55 offen lds
    s_waitcnt lgkmcnt(3)
    v_mfma_f32_32x32x16_bf16 v[16:31], v[60:63], v[76:79], v[16:31]
    ds_read_b128 v[52:55], v11
    v_mfma_f32_32x32x16_bf16 v[32:47], v[60:63], v[60:63], v[32:47]
    ds_read_b64_tr_b16 v[68:69], v105 offset:20480
    ds_read_b64_tr_b16 v[70:71], v105 offset:20736
    v_mfma_f32_32x32x16_bf16 v[116:131], v[112:115], v[60:63], v[116:131]
    s_add_u32 s57, s99, 4
    s_and_b32 s57, s57, 7
    s_mul_i32 s55, s57, 196608
    s_add_u32 s55, s55, s51
    s_add_u32 s55, s55, 2048
    s_add_u32 s56, s53, 118784
    s_mov_b32 m0, s56
    s_nop 0
    buffer_load_dwordx4 v4, s[8:11], s55 offen lds
    s_waitcnt lgkmcnt(3)
    v_mfma_f32_32x32x16_bf16 v[16:31], v[48:51], v[64:67], v[16:31]
    ds_read_b128 v[56:59], v12
    v_mfma_f32_32x32x16_bf16 v[32:47], v[48:51], v[48:51], v[32:47]
    ds_read_b64_tr_b16 v[72:73], v106 offset:20480
    ds_read_b64_tr_b16 v[74:75], v106 offset:20736
    v_mfma_f32_32x32x16_bf16 v[116:131], v[112:115], v[48:51], v[116:131]
    v_dot2c_f32_bf16 v98, s58, v64
    v_dot2c_f32_bf16 v98, s58, v65
    v_dot2c_f32_bf16 v98, s58, v66
    v_dot2c_f32_bf16 v98, s58, v67
    s_waitcnt lgkmcnt(3)
    v_mfma_f32_32x32x16_bf16 v[16:31], v[52:55], v[68:71], v[16:31]
    ds_read_b128 v[60:63], v13
    v_mfma_f32_32x32x16_bf16 v[32:47], v[52:55], v[52:55], v[32:47]
    ds_read_b64_tr_b16 v[76:77], v107 offset:20480
    ds_read_b64_tr_b16 v[78:79], v107 offset:20736
    v_mfma_f32_32x32x16_bf16 v[116:131], v[112:115], v[52:55], v[116:131]
    s_waitcnt vmcnt(6)
    s_barrier
    v_add_u32 v10, 49152, v5
    v_add_u32 v104, 49152, v100
    v_add_u32 v11, 49152, v6
    v_add_u32 v105, 49152, v101
    v_add_u32 v12, 49152, v7
    v_add_u32 v106, 49152, v102
    v_add_u32 v13, 49152, v8
    v_add_u32 v107, 49152, v103
    s_waitcnt lgkmcnt(3)
    v_mfma_f32_32x32x16_bf16 v[16:31], v[56:59], v[72:75], v[16:31]
    ds_read_b128 v[48:51], v10
    v_mfma_f32_32x32x16_bf16 v[32:47], v[56:59], v[56:59], v[32:47]
    ds_read_b64_tr_b16 v[64:65], v104 offset:20480
    ds_read_b64_tr_b16 v[66:67], v104 offset:20736
    v_mfma_f32_32x32x16_bf16 v[116:131], v[112:115], v[56:59], v[116:131]
    s_add_u32 s57, s99, 5
    s_and_b32 s57, s57, 7
    s_lshl_b32 s55, s57, 7
    s_add_u32 s56, s52, 0
    s_mov_b32 m0, s56
    s_nop 0
    buffer_load_dwordx4 v2, s[4:7], s55 offen lds
    s_add_u32 s57, s99, 5
    s_and_b32 s57, s57, 7
    s_lshl_b32 s55, s57, 7
    s_add_u32 s56, s52, 1024
    s_mov_b32 m0, s56
    s_nop 0
    buffer_load_dwordx4 v3, s[4:7], s55 offen lds
    s_waitcnt lgkmcnt(3)
    v_mfma_f32_32x32x16_bf16 v[16:31], v[60:63], v[76:79], v[16:31]
    ds_read_b128 v[52:55], v11
    v_mfma_f32_32x32x16_bf16 v[32:47], v[60:63], v[60:63], v[32:47]
    ds_read_b64_tr_b16 v[68:69], v105 offset:20480
    ds_read_b64_tr_b16 v[70:71], v105 offset:20736
    v_mfma_f32_32x32x16_bf16 v[116:131], v[112:115], v[60:63], v[116:131]
    s_add_u32 s57, s99, 5
    s_and_b32 s57, s57, 7
    s_mul_i32 s55, s57, 196608
    s_add_u32 s55, s55, s51
    s_add_u32 s55, s55, 2048
    s_add_u32 s56, s53, 20480
    s_mov_b32 m0, s56
    s_nop 0
    buffer_load_dwordx4 v4, s[8:11], s55 offen lds
    s_waitcnt lgkmcnt(3)
    v_mfma_f32_32x32x16_bf16 v[16:31], v[48:51], v[64:67], v[16:31]
    ds_read_b128 v[56:59], v12
    v_mfma_f32_32x32x16_bf16 v[32:47], v[48:51], v[48:51], v[32:47]
    ds_read_b64_tr_b16 v[72:73], v106 offset:20480
    ds_read_b64_tr_b16 v[74:75], v106 offset:20736
    v_mfma_f32_32x32x16_bf16 v[116:131], v[112:115], v[48:51], v[116:131]
    v_dot2c_f32_bf16 v98, s58, v64
    v_dot2c_f32_bf16 v98, s58, v65
    v_dot2c_f32_bf16 v98, s58, v66
    v_dot2c_f32_bf16 v98, s58, v67
    s_waitcnt lgkmcnt(3)
    v_mfma_f32_32x32x16_bf16 v[16:31], v[52:55], v[68:71], v[16:31]
    ds_read_b128 v[60:63], v13
    v_mfma_f32_32x32x16_bf16 v[32:47], v[52:55], v[52:55], v[32:47]
    ds_read_b64_tr_b16 v[76:77], v107 offset:20480
    ds_read_b64_tr_b16 v[78:79], v107 offset:20736
    v_mfma_f32_32x32x16_bf16 v[116:131], v[112:115], v[52:55], v[116:131]
    s_waitcnt vmcnt(6)
    s_barrier
    v_add_u32 v10, 73728, v5
    v_add_u32 v104, 73728, v100
    v_add_u32 v11, 73728, v6
    v_add_u32 v105, 73728, v101
    v_add_u32 v12, 73728, v7
    v_add_u32 v106, 73728, v102
    v_add_u32 v13, 73728, v8
    v_add_u32 v107, 73728, v103
    s_waitcnt lgkmcnt(3)
    v_mfma_f32_32x32x16_bf16 v[16:31], v[56:59], v[72:75], v[16:31]
    ds_read_b128 v[48:51], v10
    v_mfma_f32_32x32x16_bf16 v[32:47], v[56:59], v[56:59], v[32:47]
    ds_read_b64_tr_b16 v[64:65], v104 offset:20480
    ds_read_b64_tr_b16 v[66:67], v104 offset:20736
    v_mfma_f32_32x32x16_bf16 v[116:131], v[112:115], v[56:59], v[116:131]
    s_add_u32 s57, s99, 6
    s_and_b32 s57, s57, 7
    s_lshl_b32 s55, s57, 7
    s_add_u32 s56, s52, 24576
    s_mov_b32 m0, s56
    s_nop 0
    buffer_load_dwordx4 v2, s[4:7], s55 offen lds
    s_add_u32 s57, s99, 6
    s_and_b32 s57, s57, 7
    s_lshl_b32 s55, s57, 7
    s_add_u32 s56, s52, 25600
    s_mov_b32 m0, s56
    s_nop 0
    buffer_load_dwordx4 v3, s[4:7], s55 offen lds
    s_waitcnt lgkmcnt(3)
    v_mfma_f32_32x32x16_bf16 v[16:31], v[60:63], v[76:79], v[16:31]
    ds_read_b128 v[52:55], v11
    v_mfma_f32_32x32x16_bf16 v[32:47], v[60:63], v[60:63], v[32:47]
    ds_read_b64_tr_b16 v[68:69], v105 offset:20480
    ds_read_b64_tr_b16 v[70:71], v105 offset:20736
    v_mfma_f32_32x32x16_bf16 v[116:131], v[112:115], v[60:63], v[116:131]
    s_add_u32 s57, s99, 6
    s_and_b32 s57, s57, 7
    s_mul_i32 s55, s57, 196608
    s_add_u32 s55, s55, s51
    s_add_u32 s55, s55, 2048
    s_add_u32 s56, s53, 45056
    s_mov_b32 m0, s56
    s_nop 0
    buffer_load_dwordx4 v4, s[8:11], s55 offen lds
    s_waitcnt lgkmcnt(3)
    v_mfma_f32_32x32x16_bf16 v[16:31], v[48:51], v[64:67], v[16:31]
    ds_read_b128 v[56:59], v12
    v_mfma_f32_32x32x16_bf16 v[32:47], v[48:51], v[48:51], v[32:47]
    ds_read_b64_tr_b16 v[72:73], v106 offset:20480
    ds_read_b64_tr_b16 v[74:75], v106 offset:20736
    v_mfma_f32_32x32x16_bf16 v[116:131], v[112:115], v[48:51], v[116:131]
    v_dot2c_f32_bf16 v98, s58, v64
    v_dot2c_f32_bf16 v98, s58, v65
    v_dot2c_f32_bf16 v98, s58, v66
    v_dot2c_f32_bf16 v98, s58, v67
    s_waitcnt lgkmcnt(3)
    v_mfma_f32_32x32x16_bf16 v[16:31], v[52:55], v[68:71], v[16:31]
    ds_read_b128 v[60:63], v13
    v_mfma_f32_32x32x16_bf16 v[32:47], v[52:55], v[52:55], v[32:47]
    ds_read_b64_tr_b16 v[76:77], v107 offset:20480
    ds_read_b64_tr_b16 v[78:79], v107 offset:20736
    v_mfma_f32_32x32x16_bf16 v[116:131], v[112:115], v[52:55], v[116:131]
    s_waitcnt vmcnt(6)
    s_barrier
    v_add_u32 v10, 98304, v5
    v_add_u32 v104, 98304, v100
    v_add_u32 v11, 98304, v6
    v_add_u32 v105, 98304, v101
    v_add_u32 v12, 98304, v7
    v_add_u32 v106, 98304, v102
    v_add_u32 v13, 98304, v8
    v_add_u32 v107, 98304, v103
    s_waitcnt lgkmcnt(3)
    v_mfma_f32_32x32x16_bf16 v[16:31], v[56:59], v[72:75], v[16:31]
    ds_read_b128 v[48:51], v10
    v_mfma_f32_32x32x16_bf16 v[32:47], v[56:59], v[56:59], v[32:47]
    ds_read_b64_tr_b16 v[64:65], v104 offset:20480
    ds_read_b64_tr_b16 v[66:67], v104 offset:20736
    v_mfma_f32_32x32x16_bf16 v[116:131], v[112:115], v[56:59], v[116:131]
    s_add_u32 s57, s99, 7
    s_and_b32 s57, s57, 7
    s_lshl_b32 s55, s57, 7
    s_add_u32 s56, s52, 49152
    s_mov_b32 m0, s56
    s_nop 0
    buffer_load_dwordx4 v2, s[4:7], s55 offen lds
    s_add_u32 s57, s99, 7
    s_and_b32 s57, s57, 7
    s_lshl_b32 s55, s57, 7
    s_add_u32 s56, s52, 50176
    s_mov_b32 m0, s56
    s_nop 0
    buffer_load_dwordx4 v3, s[4:7], s55 offen lds
    s_waitcnt lgkmcnt(3)
    v_mfma_f32_32x32x16_bf16 v[16:31], v[60:63], v[76:79], v[16:31]
    ds_read_b128 v[52:55], v11
    v_mfma_f32_32x32x16_bf16 v[32:47], v[60:63], v[60:63], v[32:47]
    ds_read_b64_tr_b16 v[68:69], v105 offset:20480
    ds_read_b64_tr_b16 v[70:71], v105 offset:20736
    v_mfma_f32_32x32x16_bf16 v[116:131], v[112:115], v[60:63], v[116:131]
    s_add_u32 s57, s99, 7
    s_and_b32 s57, s57, 7
    s_mul_i32 s55, s57, 196608
    s_add_u32 s55, s55, s51
    s_add_u32 s55, s55, 2048
    s_add_u32 s56, s53, 69632
    s_mov_b32 m0, s56
    s_nop 0
    buffer_load_dwordx4 v4, s[8:11], s55 offen lds
    s_waitcnt lgkmcnt(3)
    v_mfma_f32_32x32x16_bf16 v[16:31], v[48:51], v[64:67], v[16:31]
    ds_read_b128 v[56:59], v12
    v_mfma_f32_32x32x16_bf16 v[32:47], v[48:51], v[48:51], v[32:47]
    ds_read_b64_tr_b16 v[72:73], v106 offset:20480
    ds_read_b64_tr_b16 v[74:75], v106 offset:20736
    v_mfma_f32_32x32x16_bf16 v[116:131], v[112:115], v[48:51], v[116:131]
    v_dot2c_f32_bf16 v98, s58, v64
    v_dot2c_f32_bf16 v98, s58, v65
    v_dot2c_f32_bf16 v98, s58, v66
    v_dot2c_f32_bf16 v98, s58, v67
    s_waitcnt lgkmcnt(3)
    v_mfma_f32_32x32x16_bf16 v[16:31], v[52:55], v[68:71], v[16:31]
    ds_read_b128 v[60:63], v13
    v_mfma_f32_32x32x16_bf16 v[32:47], v[52:55], v[52:55], v[32:47]
    ds_read_b64_tr_b16 v[76:77], v107 offset:20480
    ds_read_b64_tr_b16 v[78:79], v107 offset:20736
    v_mfma_f32_32x32x16_bf16 v[116:131], v[112:115], v[52:55], v[116:131]
    s_waitcnt vmcnt(6)
    s_barrier
    v_add_u32 v10, 0, v5
    v_add_u32 v104, 0, v100
    v_add_u32 v11, 0, v6
    v_add_u32 v105, 0, v101
    v_add_u32 v12, 0, v7
    v_add_u32 v106, 0, v102
    v_add_u32 v13, 0, v8
    v_add_u32 v107, 0, v103
    s_waitcnt lgkmcnt(3)
    v_mfma_f32_32x32x16_bf16 v[16:31], v[56:59], v[72:75], v[16:31]
    ds_read_b128 v[48:51], v10
    v_mfma_f32_32x32x16_bf16 v[32:47], v[56:59], v[56:59], v[32:47]
    ds_read_b64_tr_b16 v[64:65], v104 offset:20480
    ds_read_b64_tr_b16 v[66:67], v104 offset:20736
    v_mfma_f32_32x32x16_bf16 v[116:131], v[112:115], v[56:59], v[116:131]
    s_waitcnt lgkmcnt(3)
    v_mfma_f32_32x32x16_bf16 v[16:31], v[60:63], v[76:79], v[16:31]
    ds_read_b128 v[52:55], v11
    v_mfma_f32_32x32x16_bf16 v[32:47], v[60:63], v[60:63], v[32:47]
    ds_read_b64_tr_b16 v[68:69], v105 offset:20480
    ds_read_b64_tr_b16 v[70:71], v105 offset:20736
    v_mfma_f32_32x32x16_bf16 v[116:131], v[112:115], v[60:63], v[116:131]
    s_waitcnt lgkmcnt(3)
    v_mfma_f32_32x32x16_bf16 v[16:31], v[48:51], v[64:67], v[16:31]
    ds_read_b128 v[56:59], v12
    v_mfma_f32_32x32x16_bf16 v[32:47], v[48:51], v[48:51], v[32:47]
    ds_read_b64_tr_b16 v[72:73], v106 offset:20480
    ds_read_b64_tr_b16 v[74:75], v106 offset:20736
    v_mfma_f32_32x32x16_bf16 v[116:131], v[112:115], v[48:51], v[116:131]
    v_dot2c_f32_bf16 v98, s58, v64
    v_dot2c_f32_bf16 v98, s58, v65
    v_dot2c_f32_bf16 v98, s58, v66
    v_dot2c_f32_bf16 v98, s58, v67
    s_waitcnt lgkmcnt(3)
    v_mfma_f32_32x32x16_bf16 v[16:31], v[52:55], v[68:71], v[16:31]
    ds_read_b128 v[60:63], v13
    v_mfma_f32_32x32x16_bf16 v[32:47], v[52:55], v[52:55], v[32:47]
    ds_read_b64_tr_b16 v[76:77], v107 offset:20480
    ds_read_b64_tr_b16 v[78:79], v107 offset:20736
    v_mfma_f32_32x32x16_bf16 v[116:131], v[112:115], v[52:55], v[116:131]
    s_waitcnt vmcnt(3)
    s_barrier
    v_add_u32 v10, 24576, v5
    v_add_u32 v104, 24576, v100
    v_add_u32 v11, 24576, v6
    v_add_u32 v105, 24576, v101
    v_add_u32 v12, 24576, v7
    v_add_u32 v106, 24576, v102
    v_add_u32 v13, 24576, v8
    v_add_u32 v107, 24576, v103
    s_waitcnt lgkmcnt(3)
    v_mfma_f32_32x32x16_bf16 v[16:31], v[56:59], v[72:75], v[16:31]
    ds_read_b128 v[48:51], v10
    v_mfma_f32_32x32x16_bf16 v[32:47], v[56:59], v[56:59], v[32:47]
    ds_read_b64_tr_b16 v[64:65], v104 offset:20480
    ds_read_b64_tr_b16 v[66:67], v104 offset:20736
    v_mfma_f32_32x32x16_bf16 v[116:131], v[112:115], v[56:59], v[116:131]
    s_lshr_b32 s48, s2, 3
    s_lshl_b32 s48, s48, 3
    s_add_u32 s48, s48, s46
    s_and_b32 s49, s2, 1
    s_cmp_lt_u32 s48, 32
    s_cbranch_scc1 Lta_5
    s_cmp_ge_u32 s48, 144
    s_cbranch_scc1 Ltb_6
    s_sub_u32 s48, s48, 32
    s_lshl_b32 s48, s48, 6
    v_add_u32 v250, s48, v1
    v_mul_u32_u24 v251, 74899, v250
    v_lshrrev_b32 v251, 20, v251
    v_mul_u32_u24 v251, 1792, v251
    v_lshl_add_u32 v250, v250, 7, v251
    s_mul_i32 s49, s49, 1792
    buffer_load_dword v246, v250, s[16:19], s49 offen
    s_branch Ltd_7
Lta_5:
    s_sub_u32 s48, s48, 0
    s_lshl_b32 s48, s48, 14
    s_lshl_b32 s49, s49, 9
    s_add_u32 s48, s48, s49
    v_lshrrev_b32 v250, 2, v1
    v_and_b32 v251, 3, v1
    v_lshlrev_b32 v251, 7, v251
    v_lshl_add_u32 v250, v250, 10, v251
    buffer_load_dword v246, v250, s[12:15], s48 offen
    s_branch Ltd_7
Ltb_6:
    s_sub_u32 s48, s48, 144
    s_lshl_b32 s48, s48, 14
    s_lshl_b32 s49, s49, 9
    s_add_u32 s48, s48, s49
    v_lshrrev_b32 v250, 2, v1
    v_and_b32 v251, 3, v1
    v_lshlrev_b32 v251, 7, v251
    v_lshl_add_u32 v250, v250, 10, v251
    buffer_load_dword v246, v250, s[20:23], s48 offen
Ltd_7:
    s_waitcnt lgkmcnt(3)
    v_mfma_f32_32x32x16_bf16 v[16:31], v[60:63], v[76:79], v[16:31]
    ds_read_b128 v[52:55], v11
    v_mfma_f32_32x32x16_bf16 v[32:47], v[60:63], v[60:63], v[32:47]
    ds_read_b64_tr_b16 v[68:69], v105 offset:20480
    ds_read_b64_tr_b16 v[70:71], v105 offset:20736
    v_mfma_f32_32x32x16_bf16 v[116:131], v[112:115], v[60:63], v[116:131]
    s_waitcnt lgkmcnt(3)
    v_mfma_f32_32x32x16_bf16 v[16:31], v[48:51], v[64:67], v[16:31]
    ds_read_b128 v[56:59], v12
    v_mfma_f32_32x32x16_bf16 v[32:47], v[48:51], v[48:51], v[32:47]
    ds_read_b64_tr_b16 v[72:73], v106 offset:20480
    ds_read_b64_tr_b16 v[74:75], v106 offset:20736
    v_mfma_f32_32x32x16_bf16 v[116:131], v[112:115], v[48:51], v[116:131]
    v_dot2c_f32_bf16 v98, s58, v64
    v_dot2c_f32_bf16 v98, s58, v65
    v_dot2c_f32_bf16 v98, s58, v66
    v_dot2c_f32_bf16 v98, s58, v67
    s_waitcnt lgkmcnt(3)
    v_mfma_f32_32x32x16_bf16 v[16:31], v[52:55], v[68:71], v[16:31]
    ds_read_b128 v[60:63], v13
    v_mfma_f32_32x32x16_bf16 v[32:47], v[52:55], v[52:55], v[32:47]
    ds_read_b64_tr_b16 v[76:77], v107 offset:20480
    ds_read_b64_tr_b16 v[78:79], v107 offset:20736
    v_mfma_f32_32x32x16_bf16 v[116:131], v[112:115], v[52:55], v[116:131]
    s_waitcnt vmcnt(1)
    s_barrier
    v_add_u32 v10, 49152, v5
    v_add_u32 v104, 49152, v100
    v_add_u32 v11, 49152, v6
    v_add_u32 v105, 49152, v101
    v_add_u32 v12, 49152, v7
    v_add_u32 v106, 49152, v102
    v_add_u32 v13, 49152, v8
    v_add_u32 v107, 49152, v103
    s_waitcnt lgkmcnt(3)
    v_mfma_f32_32x32x16_bf16 v[16:31], v[56:59], v[72:75], v[16:31]
    ds_read_b128 v[48:51], v10
    v_mfma_f32_32x32x16_bf16 v[32:47], v[56:59], v[56:59], v[32:47]
    ds_read_b64_tr_b16 v[64:65], v104 offset:20480
    ds_read_b64_tr_b16 v[66:67], v104 offset:20736
    v_mfma_f32_32x32x16_bf16 v[116:131], v[112:115], v[56:59], v[116:131]
    s_waitcnt lgkmcnt(3)
    v_mfma_f32_32x32x16_bf16 v[16:31], v[60:63], v[76:79], v[16:31]
    ds_read_b128 v[52:55], v11
    v_mfma_f32_32x32x16_bf16 v[32:47], v[60:63], v[60:63], v[32:47]
    ds_read_b64_tr_b16 v[68:69], v105 offset:20480
    ds_read_b64_tr_b16 v[70:71], v105 offset:20736
    v_mfma_f32_32x32x16_bf16 v[116:131], v[112:115], v[60:63], v[116:131]
    s_waitcnt lgkmcnt(3)
    v_mfma_f32_32x32x16_bf16 v[16:31], v[48:51], v[64:67], v[16:31]
    ds_read_b128 v[56:59], v12
    v_mfma_f32_32x32x16_bf16 v[32:47], v[48:51], v[48:51], v[32:47]
    ds_read_b64_tr_b16 v[72:73], v106 offset:20480
    ds_read_b64_tr_b16 v[74:75], v106 offset:20736
    v_mfma_f32_32x32x16_bf16 v[116:131], v[112:115], v[48:51], v[116:131]
    v_dot2c_f32_bf16 v98, s58, v64
    v_dot2c_f32_bf16 v98, s58, v65
    v_dot2c_f32_bf16 v98, s58, v66
    v_dot2c_f32_bf16 v98, s58, v67
    s_waitcnt lgkmcnt(3)
    v_mfma_f32_32x32x16_bf16 v[16:31], v[52:55], v[68:71], v[16:31]
    ds_read_b128 v[60:63], v13
    v_mfma_f32_32x32x16_bf16 v[32:47], v[52:55], v[52:55], v[32:47]
    ds_read_b64_tr_b16 v[76:77], v107 offset:20480
    ds_read_b64_tr_b16 v[78:79], v107 offset:20736
    v_mfma_f32_32x32x16_bf16 v[116:131], v[112:115], v[52:55], v[116:131]
    s_waitcnt lgkmcnt(3)
    v_mfma_f32_32x32x16_bf16 v[16:31], v[56:59], v[72:75], v[16:31]
    v_mfma_f32_32x32x16_bf16 v[32:47], v[56:59], v[56:59], v[32:47]
    v_mfma_f32_32x32x16_bf16 v[116:131], v[112:115], v[56:59], v[116:131]
    s_waitcnt lgkmcnt(0)
    v_mfma_f32_32x32x16_bf16 v[16:31], v[60:63], v[76:79], v[16:31]
    v_mfma_f32_32x32x16_bf16 v[32:47], v[60:63], v[60:63], v[32:47]
    v_mfma_f32_32x32x16_bf16 v[116:131], v[112:115], v[60:63], v[116:131]
    s_nop 7
    v_and_b32 v10, 31, v1
    v_lshlrev_b32 v11, 2, v10
    v_add_u32 v11, 156672, v11
    ds_add_f32 v11, v98 offset:256
    v_lshrrev_b32 v12, 3, v10
    v_and_b32 v13, 3, v10
    v_lshl_add_u32 v12, v12, 2, v13
    v_mov_b32 v97, v32
    v_cmp_eq_u32 s[64:65], 1, v12
    v_cmp_eq_u32 s[66:67], 2, v12
    v_cmp_eq_u32 s[68:69], 3, v12
    v_cmp_eq_u32 s[70:71], 4, v12
    v_cmp_eq_u32 s[72:73], 5, v12
    v_cmp_eq_u32 s[74:75], 6, v12
    v_cmp_eq_u32 s[76:77], 7, v12
    v_cmp_eq_u32 s[78:79], 8, v12
    v_cmp_eq_u32 s[80:81], 9, v12
    v_cmp_eq_u32 s[82:83], 10, v12
    v_cmp_eq_u32 s[84:85], 11, v12
    v_cmp_eq_u32 s[86:87], 12, v12
    v_cmp_eq_u32 s[88:89], 13, v12
    v_cmp_eq_u32 s[90:91], 14, v12
    v_cmp_eq_u32 s[92:93], 15, v12
    v_cndmask_b32 v97, v97, v33, s[64:65]
    v_cndmask_b32 v97, v97, v34, s[66:67]
    v_cndmask_b32 v97, v97, v35, s[68:69]
    v_cndmask_b32 v97, v97, v36, s[70:71]
    v_cndmask_b32 v97, v97, v37, s[72:73]
    v_cndmask_b32 v97, v97, v38, s[74:75]
    v_cndmask_b32 v97, v97, v39, s[76:77]
    v_cndmask_b32 v97, v97, v40, s[78:79]
    v_cndmask_b32 v97, v97, v41, s[80:81]
    v_cndmask_b32 v97, v97, v42, s[82:83]
    v_cndmask_b32 v97, v97, v43, s[84:85]
    v_cndmask_b32 v97, v97, v44, s[86:87]
    v_cndmask_b32 v97, v97, v45, s[88:89]
    v_cndmask_b32 v97, v97, v46, s[90:91]
    v_cndmask_b32 v97, v97, v47, s[92:93]
    v_mov_b32 v96, v116
    v_mul_f32 v96, 0x3b000000, v96
    v_mul_f32 v97, 0x3b000000, v97
    v_fma_f32 v97, -v96, v96, v97
    v_max_f32 v97, 0, v97
    v_add_f32 v97, 0x3727c5ac, v97
    v_rsq_f32 v97, v97
    v_add_u32 v11, s54, v10
    v_lshlrev_b32 v11, 2, v11
    v_mul_f32 v96, v96, v97
    v_add_u32 v11, 155648, v11
    v_sub_f32 v96, 0, v96
    s_mov_b32 exec_lo, 0x0f0f0f0f
    s_mov_b32 exec_hi, 0xf0f0f0f0
    ds_write_b32 v11, v97
    ds_write_b32 v11, v96 offset:512
    s_mov_b64 exec, -1
    s_waitcnt lgkmcnt(0)
    s_barrier
    v_lshrrev_b32 v13, 5, v1
    v_lshlrev_b32 v15, 4, v1
    s_lshl_b32 s55, s44, 4
    s_add_u32 s55, s55, s45
    s_lshl_b32 s55, s55, 14
    s_lshl_b32 s56, s50, 11
    s_add_u32 s55, s55, s56
    s_add_u32 s55, s55, 73728
    v_lshlrev_b32 v11, 2, v10
    v_add_u32 v11, 156928, v11
    v_lshlrev_b32 v12, 4, v13
    s_lshl_b32 s57, s54, 2
    v_add_u32 v12, s57, v12
    v_add_u32 v12, 155648, v12
    ds_read_b32 v96, v11
    ds_read_b128 v[48:51], v12 offset:0
    ds_read_b128 v[52:55], v12 offset:32
    ds_read_b128 v[56:59], v12 offset:64
    ds_read_b128 v[60:63], v12 offset:96
    ds_read_b128 v[64:67], v12 offset:512
    ds_read_b128 v[68:71], v12 offset:544
    ds_read_b128 v[72:75], v12 offset:576
    ds_read_b128 v[76:79], v12 offset:608
    v_add_u32 v14, s56, v15
    v_mov_b32 v88, s58
    v_mov_b32 v89, s58
    v_mov_b32 v90, s58
    v_mov_b32 v91, s58
    s_waitcnt lgkmcnt(0)
    v_mul_f32 v64, v96, v64
    v_fma_f32 v16, v16, v48, v64
    v_mul_f32 v65, v96, v65
    v_fma_f32 v17, v17, v49, v65
    v_mul_f32 v66, v96, v66
    v_fma_f32 v18, v18, v50, v66
    v_mul_f32 v67, v96, v67
    v_fma_f32 v19, v19, v51, v67
    v_mul_f32 v68, v96, v68
    v_fma_f32 v20, v20, v52, v68
    v_mul_f32 v69, v96, v69
    v_fma_f32 v21, v21, v53, v69
    v_mul_f32 v70, v96, v70
    v_fma_f32 v22, v22, v54, v70
    v_mul_f32 v71, v96, v71
    v_fma_f32 v23, v23, v55, v71
    v_mul_f32 v72, v96, v72
    v_fma_f32 v24, v24, v56, v72
    v_mul_f32 v73, v96, v73
    v_fma_f32 v25, v25, v57, v73
    v_mul_f32 v74, v96, v74
    v_fma_f32 v26, v26, v58, v74
    v_mul_f32 v75, v96, v75
    v_fma_f32 v27, v27, v59, v75
    v_mul_f32 v76, v96, v76
    v_fma_f32 v28, v28, v60, v76
    v_mul_f32 v77, v96, v77
    v_fma_f32 v29, v29, v61, v77
    v_mul_f32 v78, v96, v78
    v_fma_f32 v30, v30, v62, v78
    v_mul_f32 v79, v96, v79
    v_fma_f32 v31, v31, v63, v79
    v_cvt_pk_bf16_f32 v80, v16, v17
    v_cvt_pk_bf16_f32 v81, v18, v19
    v_cvt_pk_bf16_f32 v82, v20, v21
    v_cvt_pk_bf16_f32 v83, v22, v23
    v_cvt_pk_bf16_f32 v84, v24, v25
    v_cvt_pk_bf16_f32 v85, v26, v27
    v_cvt_pk_bf16_f32 v86, v28, v29
    v_cvt_pk_bf16_f32 v87, v30, v31
    buffer_store_dwordx4 v[80:83], v15, s[40:43], s55 offen offset:0 sc1
    ds_write_b128 v14, v[80:83] offset:40960
    buffer_store_dwordx4 v[84:87], v15, s[40:43], s55 offen offset:1024 sc1
    ds_write_b128 v14, v[84:87] offset:41984
    ds_write_b128 v15, v[88:91] offset:49152
    ds_write_b128 v15, v[88:91] offset:50176
    v_add_u32 v104, 122880, v100
    v_mov_b32 v98, 0
    ds_read_b64_tr_b16 v[48:49], v104 offset:0
    ds_read_b64_tr_b16 v[50:51], v104 offset:256
    ds_read_b64_tr_b16 v[52:53], v104 offset:4096
    ds_read_b64_tr_b16 v[54:55], v104 offset:4352
    ds_read_b64_tr_b16 v[56:57], v104 offset:8192
    ds_read_b64_tr_b16 v[58:59], v104 offset:8448
    ds_read_b64_tr_b16 v[60:61], v104 offset:12288
    ds_read_b64_tr_b16 v[62:63], v104 offset:12544
    ds_read_b64_tr_b16 v[64:65], v104 offset:16384
    ds_read_b64_tr_b16 v[66:67], v104 offset:16640
    ds_read_b64_tr_b16 v[68:69], v104 offset:20480
    ds_read_b64_tr_b16 v[70:71], v104 offset:20736
    ds_read_b64_tr_b16 v[72:73], v104 offset:24576
    ds_read_b64_tr_b16 v[74:75], v104 offset:24832
    ds_read_b64_tr_b16 v[76:77], v104 offset:28672
    ds_read_b64_tr_b16 v[78:79], v104 offset:28928
    s_waitcnt lgkmcnt(0)
    v_dot2c_f32_bf16 v98, s58, v48
    v_dot2c_f32_bf16 v98, s58, v49
    v_dot2c_f32_bf16 v98, s58, v50
    v_dot2c_f32_bf16 v98, s58, v51
    v_dot2c_f32_bf16 v98, s58, v52
    v_dot2c_f32_bf16 v98, s58, v53
    v_dot2c_f32_bf16 v98, s58, v54
    v_dot2c_f32_bf16 v98, s58, v55
    v_dot2c_f32_bf16 v98, s58, v56
    v_dot2c_f32_bf16 v98, s58, v57
    v_dot2c_f32_bf16 v98, s58, v58
    v_dot2c_f32_bf16 v98, s58, v59
    v_dot2c_f32_bf16 v98, s58, v60
    v_dot2c_f32_bf16 v98, s58, v61
    v_dot2c_f32_bf16 v98, s58, v62
    v_dot2c_f32_bf16 v98, s58, v63
    v_dot2c_f32_bf16 v98, s58, v64
    v_dot2c_f32_bf16 v98, s58, v65
    v_dot2c_f32_bf16 v98, s58, v66
    v_dot2c_f32_bf16 v98, s58, v67
    v_dot2c_f32_bf16 v98, s58, v68
    v_dot2c_f32_bf16 v98, s58, v69
    v_dot2c_f32_bf16 v98, s58, v70
    v_dot2c_f32_bf16 v98, s58, v71
    v_dot2c_f32_bf16 v98, s58, v72
    v_dot2c_f32_bf16 v98, s58, v73
    v_dot2c_f32_bf16 v98, s58, v74
    v_dot2c_f32_bf16 v98, s58, v75
    v_dot2c_f32_bf16 v98, s58, v76
    v_dot2c_f32_bf16 v98, s58, v77
    v_dot2c_f32_bf16 v98, s58, v78
    v_dot2c_f32_bf16 v98, s58, v79
    v_subrev_u32 v11, 256, v11
    s_nop 1
    ds_add_f32 v11, v98
Lp1done:
    s_waitcnt vmcnt(0)
    s_cmp_lg_u32 s46, 0
    s_cbranch_scc1 Lpl_8
    s_mov_b32 s48, 0
    v_readfirstlane_b32 s47, v249
    v_mov_b32 v251, 0
    s_cmp_lg_u32 s47, 0
    s_cbranch_scc1 Lpl_8
    s_mov_b64 exec, 1
Lpp_9:
    buffer_load_dword v250, v251, s[36:39], 0 offen sc1
    s_waitcnt vmcnt(0)
    v_cmp_eq_u32 vcc, 0, v250
    s_cmp_eq_u64 vcc, 0
    s_cbranch_scc1 Lpd_10
    s_add_u32 s48, s48, 1
    s_cmp_lt_u32 s48, 400000
    s_cbranch_scc1 Lpp_9
    Lpd_10:
    v_readfirstlane_b32 s47, v250
    s_mov_b64 exec, -1
Lpl_8:
    s_waitcnt lgkmcnt(0)
    s_barrier
    s_cmp_lg_u32 s46, 0
    s_cbranch_scc1 Lsf_11
    s_lshl_b32 s48, s44, 10
    s_lshl_b32 s49, s45, 6
    s_add_u32 s48, s48, s49
    s_add_u32 s48, s48, 0
    v_mov_b32 v250, s47
    v_lshl_add_u32 v251, v1, 2, s48
    s_mov_b64 exec, 0xffff
    buffer_store_dword v250, v251, s[40:43], 0 offen sc1
    s_mov_b64 exec, -1
    Lsf_11:
    s_cmp_lg_u32 s46, 0
    s_cbranch_scc1 Lpr_12
    s_setprio 3
Lpr_12:
    s_cmp_ge_u32 s46, 4
    s_cbranch_scc1 Lqe_13
    ds_read_b128 v[32:35], v12 offset:0
    ds_read_b128 v[36:39], v12 offset:32
    ds_read_b128 v[40:43], v12 offset:64
    ds_read_b128 v[44:47], v12 offset:96
    v_add_u32 v14, s53, v15
    s_waitcnt lgkmcnt(0)
    v_mul_f32 v32, v99, v32
    v_fma_f32 v16, v16, v98, v32
    v_mul_f32 v33, v99, v33
    v_fma_f32 v17, v17, v98, v33
    v_mul_f32 v34, v99, v34
    v_fma_f32 v18, v18, v98, v34
    v_mul_f32 v35, v99, v35
    v_fma_f32 v19, v19, v98, v35
    v_mul_f32 v36, v99, v36
    v_fma_f32 v20, v20, v98, v36
    v_mul_f32 v37, v99, v37
    v_fma_f32 v21, v21, v98, v37
    v_mul_f32 v38, v99, v38
    v_fma_f32 v22, v22, v98, v38
    v_mul_f32 v39, v99, v39
    v_fma_f32 v23, v23, v98, v39
    v_mul_f32 v40, v99, v40
    v_fma_f32 v24, v24, v98, v40
    v_mul_f32 v41, v99, v41
    v_fma_f32 v25, v25, v98, v41
    v_mul_f32 v42, v99, v42
    v_fma_f32 v26, v26, v98, v42
    v_mul_f32 v43, v99, v43
    v_fma_f32 v27, v27, v98, v43
    v_mul_f32 v44, v99, v44
    v_fma_f32 v28, v28, v98, v44
    v_mul_f32 v45, v99, v45
    v_fma_f32 v29, v29, v98, v45
    v_mul_f32 v46, v99, v46
    v_fma_f32 v30, v30, v98, v46
    v_mul_f32 v47, v99, v47
    v_fma_f32 v31, v31, v98, v47
    v_cvt_pk_bf16_f32 v100, v16, v17
    v_cvt_pk_bf16_f32 v101, v18, v19
    v_cvt_pk_bf16_f32 v102, v20, v21
    v_cvt_pk_bf16_f32 v103, v22, v23
    v_cvt_pk_bf16_f32 v104, v24, v25
    v_cvt_pk_bf16_f32 v105, v26, v27
    v_cvt_pk_bf16_f32 v106, v28, v29
    v_cvt_pk_bf16_f32 v107, v30, v31
    ds_write_b128 v14, v[104:107] offset:51200
Lqe_13:
    v_mov_b32 v244, 0
    s_mov_b32 s97, 0
    s_mov_b32 s63, 74899
    v_mov_b32 v243, 3360
    s_mul_i32 s59, s45, 224
    s_lshr_b32 s86, s46, 2
    s_sub_u32 s87, 3, s50
    s_cmp_ge_u32 s46, 4
    s_cselect_b32 s87, s87, s50
    v_and_b32 v10, 31, v1
    v_lshrrev_b32 v13, 5, v1
    v_lshlrev_b32 v13, 2, v13
    v_sub_u32 v10, v10, v13
    v_mov_b32 v11, 0xf149f2ca
    v_cmp_gt_i32 s[64:65], 0, v10
    v_cmp_gt_i32 s[66:67], 1, v10
    v_cmp_gt_i32 s[68:69], 2, v10
    v_cmp_gt_i32 s[70:71], 3, v10
    v_cmp_gt_i32 s[72:73], 8, v10
    v_cmp_gt_i32 s[74:75], 9, v10
    v_cmp_gt_i32 s[76:77], 10, v10
    v_cmp_gt_i32 s[78:79], 11, v10
    v_cmp_gt_i32 s[80:81], 16, v10
    v_cmp_gt_i32 s[82:83], 17, v10
    v_cmp_gt_i32 s[88:89], 18, v10
    v_cmp_gt_i32 s[90:91], 19, v10
    v_cmp_gt_i32 s[92:93], 24, v10
    v_cmp_gt_i32 s[94:95], 25, v10
    v_cmp_gt_i32 s[98:99], 26, v10
    v_cmp_gt_i32 s[100:101], 27, v10
    s_lshl_b32 s48, s86, 10
    s_lshl_b32 s49, s87, 11
    s_add_u32 s55, s48, s49
    s_add_u32 s55, s55, 16384
    v_add_u32 v132, s55, v15
    s_lshl_b32 s48, s86, 8
    v_xor_b32 v133, s48, v15
    s_add_u32 s49, s49, 40960
    v_add_u32 v133, s49, v133
    v_add_u32 v12, 49152, v15
    v_and_b32 v13, 16, v1
    v_cmp_eq_u32 vcc, 0, v13
    v_mov_b32 v14, 0xfffff800
    s_mov_b32 s61, 0xfffff800
    v_cndmask_b32 v133, v12, v133, vcc
    v_cndmask_b32 v131, 0, v14, vcc
    s_add_u32 s60, s87, 1
    v_mov_b32 v128, v11
    v_cndmask_b32 v80, 0, v11, s[64:65]
    v_cndmask_b32 v81, 0, v11, s[66:67]
    v_cndmask_b32 v82, 0, v11, s[68:69]
    v_cndmask_b32 v83, 0, v11, s[70:71]
    v_cndmask_b32 v84, 0, v11, s[72:73]
    v_cndmask_b32 v85, 0, v11, s[74:75]
    v_cndmask_b32 v86, 0, v11, s[76:77]
    v_cndmask_b32 v87, 0, v11, s[78:79]
    v_cndmask_b32 v88, 0, v11, s[80:81]
    v_cndmask_b32 v89, 0, v11, s[82:83]
    v_cndmask_b32 v90, 0, v11, s[88:89]
    v_cndmask_b32 v91, 0, v11, s[90:91]
    v_cndmask_b32 v92, 0, v11, s[92:93]
    v_cndmask_b32 v93, 0, v11, s[94:95]
    v_cndmask_b32 v94, 0, v11, s[98:99]
    v_cndmask_b32 v95, 0, v11, s[100:101]
    v_mov_b32 v48, 0
    v_mov_b32 v49, 0
    v_mov_b32 v50, 0
    v_mov_b32 v51, 0
    v_mov_b32 v52, 0
    v_mov_b32 v53, 0
    v_mov_b32 v54, 0
    v_mov_b32 v55, 0
    v_mov_b32 v56, 0
    v_mov_b32 v57, 0
    v_mov_b32 v58, 0
    v_mov_b32 v59, 0
    v_mov_b32 v60, 0
    v_mov_b32 v61, 0
    v_mov_b32 v62, 0
    v_mov_b32 v63, 0
    s_waitcnt lgkmcnt(0)
    s_barrier
    s_cmp_lt_u32 s46, 4
    s_cbranch_scc1 Lq_14
    s_lshl_b32 s48, s87, 10
    v_add_u32 v12, s48, v15
    ds_read_b128 v[100:103], v12 offset:51200
    s_waitcnt lgkmcnt(0)
    Lq_14:
    s_mov_b32 s62, s60
    v_add_u32 v129, s61, v132
    ds_read_b128 v[104:107], v132
    ds_read_b128 v[108:111], v129
    v_mov_b32 v134, v128
    s_waitcnt lgkmcnt(1)
    v_mfma_f32_32x32x16_bf16 v[16:31], v[104:107], v[100:103], v[80:95]
La1_15:
    s_sub_u32 s62, s62, 1
    s_cmp_eq_u32 s62, 0
    s_cbranch_scc1 Lt0_16
    v_add_u32 v129, s61, v129
    s_waitcnt lgkmcnt(0)
    v_mfma_f32_32x32x16_bf16 v[32:47], v[108:111], v[100:103], 0
    ds_read_b128 v[104:107], v129
    s_nop 4
    v_max3_f32 v128, v16, v17, v128
    v_max3_f32 v128, v18, v19, v128
    v_max3_f32 v128, v20, v21, v128
    v_max3_f32 v128, v22, v23, v128
    v_max3_f32 v128, v24, v25, v128
    v_max3_f32 v128, v26, v27, v128
    v_max3_f32 v128, v28, v29, v128
    v_max3_f32 v128, v30, v31, v128
    s_sub_u32 s62, s62, 1
    s_cmp_eq_u32 s62, 0
    s_cbranch_scc1 Lt1_17
    v_add_u32 v129, s61, v129
    s_waitcnt lgkmcnt(0)
    v_mfma_f32_32x32x16_bf16 v[16:31], v[104:107], v[100:103], 0
    ds_read_b128 v[108:111], v129
    s_nop 4
    v_max3_f32 v128, v32, v33, v128
    v_max3_f32 v128, v34, v35, v128
    v_max3_f32 v128, v36, v37, v128
    v_max3_f32 v128, v38, v39, v128
    v_max3_f32 v128, v40, v41, v128
    v_max3_f32 v128, v42, v43, v128
    v_max3_f32 v128, v44, v45, v128
    v_max3_f32 v128, v46, v47, v128
    s_branch La1_15
Lt0_16:
    s_nop 9
    v_max3_f32 v128, v16, v17, v128
    v_max3_f32 v128, v18, v19, v128
    v_max3_f32 v128, v20, v21, v128
    v_max3_f32 v128, v22, v23, v128
    v_max3_f32 v128, v24, v25, v128
    v_max3_f32 v128, v26, v27, v128
    v_max3_f32 v128, v28, v29, v128
    v_max3_f32 v128, v30, v31, v128
    s_branch Ldn_18
Lt1_17:
    s_nop 9
    v_max3_f32 v128, v32, v33, v128
    v_max3_f32 v128, v34, v35, v128
    v_max3_f32 v128, v36, v37, v128
    v_max3_f32 v128, v38, v39, v128
    v_max3_f32 v128, v40, v41, v128
    v_max3_f32 v128, v42, v43, v128
    v_max3_f32 v128, v44, v45, v128
    v_max3_f32 v128, v46, v47, v128
Ldn_18:
    v_add_u32 v129, s61, v132
    s_waitcnt lgkmcnt(0)
    ds_read_b128 v[104:107], v132
    ds_read_b128 v[108:111], v129
    v_mov_b32 v135, v128
    s_mov_b32 s62, s60
    v_mov_b32 v130, v133
    v_permlane32_swap_b32 v128, v135
    v_max_f32 v128, v128, v135
    v_sub_f32 v80, v80, v128
    v_sub_f32 v81, v81, v128
    v_sub_f32 v82, v82, v128
    v_sub_f32 v83, v83, v128
    v_sub_f32 v84, v84, v128
    v_sub_f32 v85, v85, v128
    v_sub_f32 v86, v86, v128
    v_sub_f32 v87, v87, v128
    v_sub_f32 v88, v88, v128
    v_sub_f32 v89, v89, v128
    v_sub_f32 v90, v90, v128
    v_sub_f32 v91, v91, v128
    v_sub_f32 v92, v92, v128
    v_sub_f32 v93, v93, v128
    v_sub_f32 v94, v94, v128
    v_sub_f32 v95, v95, v128
    v_sub_f32 v64, 0, v128
    v_sub_f32 v65, 0, v128
    v_sub_f32 v66, 0, v128
    v_sub_f32 v67, 0, v128
    v_sub_f32 v68, 0, v128
    v_sub_f32 v69, 0, v128
    v_sub_f32 v70, 0, v128
    v_sub_f32 v71, 0, v128
    v_sub_f32 v72, 0, v128
    v_sub_f32 v73, 0, v128
    v_sub_f32 v74, 0, v128
    v_sub_f32 v75, 0, v128
    v_sub_f32 v76, 0, v128
    v_sub_f32 v77, 0, v128
    v_sub_f32 v78, 0, v128
    v_sub_f32 v79, 0, v128
    s_waitcnt lgkmcnt(1)
    v_mfma_f32_32x32x16_bf16 v[16:31], v[104:107], v[100:103], v[80:95]
La2_19:
    ds_read_b128 v[112:115], v130
    ds_read_b128 v[116:119], v130 offset:1024
    v_add_u32 v129, s61, v129
    s_waitcnt lgkmcnt(2)
    v_mfma_f32_32x32x16_bf16 v[32:47], v[108:111], v[100:103], v[64:79]
    ds_read_b128 v[104:107], v129
    v_add_u32 v130, v131, v130
    s_sub_u32 s62, s62, 1
    s_nop 3
    v_exp_f32 v16, v16
    v_exp_f32 v17, v17
    v_exp_f32 v18, v18
    v_exp_f32 v19, v19
    v_exp_f32 v20, v20
    v_exp_f32 v21, v21
    v_exp_f32 v22, v22
    v_exp_f32 v23, v23
    v_exp_f32 v24, v24
    v_exp_f32 v25, v25
    v_exp_f32 v26, v26
    v_exp_f32 v27, v27
    v_exp_f32 v28, v28
    v_exp_f32 v29, v29
    v_exp_f32 v30, v30
    v_exp_f32 v31, v31
    v_cvt_pk_bf16_f32 v120, v16, v17
    v_cvt_pk_bf16_f32 v121, v18, v19
    v_cvt_pk_bf16_f32 v122, v20, v21
    v_cvt_pk_bf16_f32 v123, v22, v23
    v_cvt_pk_bf16_f32 v124, v24, v25
    v_cvt_pk_bf16_f32 v125, v26, v27
    v_cvt_pk_bf16_f32 v126, v28, v29
    v_cvt_pk_bf16_f32 v127, v30, v31
    s_waitcnt lgkmcnt(1)
    s_cmp_eq_u32 s62, 0
    v_mfma_f32_32x32x16_bf16 v[48:63], v[112:115], v[120:123], v[48:63]
    v_mfma_f32_32x32x16_bf16 v[48:63], v[116:119], v[124:127], v[48:63]
    s_cbranch_scc1 Ld2_20
    ds_read_b128 v[112:115], v130
    ds_read_b128 v[116:119], v130 offset:1024
    v_add_u32 v129, s61, v129
    s_waitcnt lgkmcnt(2)
    v_mfma_f32_32x32x16_bf16 v[16:31], v[104:107], v[100:103], v[64:79]
    ds_read_b128 v[108:111], v129
    v_add_u32 v130, v131, v130
    s_sub_u32 s62, s62, 1
    s_nop 3
    v_exp_f32 v32, v32
    v_exp_f32 v33, v33
    v_exp_f32 v34, v34
    v_exp_f32 v35, v35
    v_exp_f32 v36, v36
    v_exp_f32 v37, v37
    v_exp_f32 v38, v38
    v_exp_f32 v39, v39
    v_exp_f32 v40, v40
    v_exp_f32 v41, v41
    v_exp_f32 v42, v42
    v_exp_f32 v43, v43
    v_exp_f32 v44, v44
    v_exp_f32 v45, v45
    v_exp_f32 v46, v46
    v_exp_f32 v47, v47
    v_cvt_pk_bf16_f32 v120, v32, v33
    v_cvt_pk_bf16_f32 v121, v34, v35
    v_cvt_pk_bf16_f32 v122, v36, v37
    v_cvt_pk_bf16_f32 v123, v38, v39
    v_cvt_pk_bf16_f32 v124, v40, v41
    v_cvt_pk_bf16_f32 v125, v42, v43
    v_cvt_pk_bf16_f32 v126, v44, v45
    v_cvt_pk_bf16_f32 v127, v46, v47
    s_waitcnt lgkmcnt(1)
    s_cmp_eq_u32 s62, 0
    v_mfma_f32_32x32x16_bf16 v[48:63], v[112:115], v[120:123], v[48:63]
    v_mfma_f32_32x32x16_bf16 v[48:63], v[116:119], v[124:127], v[48:63]
    s_cbranch_scc1 Ld2_20
    s_branch La2_19
Ld2_20:
    s_waitcnt lgkmcnt(0)
    s_cmp_lg_u32 s46, 0
    s_cbranch_scc1 Lpl_21
    s_mov_b32 s48, 0
    v_sub_u32 v251, s44, v1
    v_subrev_u32 v251, 1, v251
    v_mov_b32 v250, s44
    v_cmp_gt_i32 vcc, 0, v251
    s_lshl_b32 s49, s45, 6
    s_nop 0
    v_cndmask_b32 v251, v251, v250, vcc
    v_lshl_add_u32 v251, v251, 10, s49
    s_mov_b64 exec, 3
    buffer_load_dword v248, v251, s[40:43], 0 offen sc1
    buffer_load_dword v247, v251, s[40:43], 0 offen sc1
    buffer_load_dword v246, v251, s[40:43], 0 offen sc1
Lpp_22:
    buffer_load_dword v250, v251, s[40:43], 0 offen sc1
    s_waitcnt vmcnt(3)
    v_cmp_ne_u32 vcc, s47, v248
    s_cmp_eq_u64 vcc, 0
    s_cbranch_scc1 Lpd_23
    buffer_load_dword v248, v251, s[40:43], 0 offen sc1
    s_waitcnt vmcnt(3)
    v_cmp_ne_u32 vcc, s47, v247
    s_cmp_eq_u64 vcc, 0
    s_cbranch_scc1 Lpd_23
    buffer_load_dword v247, v251, s[40:43], 0 offen sc1
    s_waitcnt vmcnt(3)
    v_cmp_ne_u32 vcc, s47, v246
    s_cmp_eq_u64 vcc, 0
    s_cbranch_scc1 Lpd_23
    buffer_load_dword v246, v251, s[40:43], 0 offen sc1
    s_waitcnt vmcnt(3)
    v_cmp_ne_u32 vcc, s47, v250
    s_cmp_eq_u64 vcc, 0
    s_cbranch_scc1 Lpd_23
    s_add_u32 s48, s48, 1
    s_cmp_lt_u32 s48, 400000
    s_cbranch_scc1 Lpp_22
    Lpd_23:
    s_mov_b64 exec, -1
Lpl_21:
    s_cmp_lg_u32 s46, 0
    s_cbranch_scc1 Lnz_24
    s_cmp_lt_u32 s44, 1
    s_cbranch_scc1 Lnb_25
    s_sub_u32 s48, s44, 1
    s_lshl_b32 s48, s48, 4
    s_add_u32 s48, s48, s45
    s_lshl_b32 s48, s48, 14
    s_add_u32 s48, s48, 65536
    s_movk_i32 s55, 8192
        Lnl_26:
    s_add_u32 s49, s48, 8192
    s_add_u32 s56, s55, 24576
    s_mov_b32 m0, s55
    s_nop 0
    buffer_load_dwordx4 v15, s[40:43], s48 offen sc1 lds
    s_mov_b32 m0, s56
    s_nop 0
    buffer_load_dwordx4 v15, s[40:43], s49 offen sc1 lds
    s_add_u32 s48, s48, 1024
    s_add_u32 s55, s55, 1024
    s_cmp_lt_u32 s55, 16384
    s_cbranch_scc1 Lnl_26
Lnb_25:
    s_cmp_lt_u32 s44, 2
    s_cbranch_scc1 Lnb_27
    s_sub_u32 s48, s44, 2
    s_lshl_b32 s48, s48, 4
    s_add_u32 s48, s48, s45
    s_lshl_b32 s48, s48, 14
    s_add_u32 s48, s48, 65536
    s_movk_i32 s55, 0
        Lnl_28:
    s_add_u32 s49, s48, 8192
    s_add_u32 s56, s55, 24576
    s_mov_b32 m0, s55
    s_nop 0
    buffer_load_dwordx4 v15, s[40:43], s48 offen sc1 lds
    s_mov_b32 m0, s56
    s_nop 0
    buffer_load_dwordx4 v15, s[40:43], s49 offen sc1 lds
    s_add_u32 s48, s48, 1024
    s_add_u32 s55, s55, 1024
    s_cmp_lt_u32 s55, 8192
    s_cbranch_scc1 Lnl_28
Lnb_27:
    s_setprio 0
Lnz_24:
    s_lshr_b32 s49, s45, 1
    s_lshl_b32 s49, s49, 7
    v_lshrrev_b32 v12, 2, v1
    v_lshlrev_b32 v12, 10, v12
    v_and_b32 v13, 3, v1
    v_lshl_add_u32 v12, v13, 4, v12
    v_add_u32 v136, s49, v12
    s_lshl_b32 s48, s86, 6
    s_lshl_b32 s49, s50, 17
    s_add_u32 s3, s48, s49
    s_lshl_b32 s54, s46, 13
    s_add_u32 s54, s54, 98304
    s_add_u32 s53, s54, 8192
    s_cmp_ge_u32 s44, 2
    s_cselect_b32 s48, s87, 4
    s_cselect_b32 s49, 0xf149f2ca, 0
    s_sub_u32 s60, 8, s48
    s_movk_i32 s61, 2048
    s_sub_u32 s48, s48, s87
    s_sub_u32 s48, s48, 8
    s_lshl_b32 s48, s48, 11
    v_mov_b32 v11, s49
    v_add_u32 v132, s48, v132
    v_sub_u32 v131, 0, v131
    v_lshrrev_b32 v12, 11, v131
    v_mul_lo_u32 v12, v12, s48
    v_add_u32 v133, v12, v133
    v_cndmask_b32 v80, v11, 0, s[64:65]
    v_cndmask_b32 v81, v11, 0, s[66:67]
    v_cndmask_b32 v82, v11, 0, s[68:69]
    v_cndmask_b32 v83, v11, 0, s[70:71]
    v_cndmask_b32 v84, v11, 0, s[72:73]
    v_cndmask_b32 v85, v11, 0, s[74:75]
    v_cndmask_b32 v86, v11, 0, s[76:77]
    v_cndmask_b32 v87, v11, 0, s[78:79]
    v_cndmask_b32 v88, v11, 0, s[80:81]
    v_cndmask_b32 v89, v11, 0, s[82:83]
    v_cndmask_b32 v90, v11, 0, s[88:89]
    v_cndmask_b32 v91, v11, 0, s[90:91]
    v_cndmask_b32 v92, v11, 0, s[92:93]
    v_cndmask_b32 v93, v11, 0, s[94:95]
    v_cndmask_b32 v94, v11, 0, s[98:99]
    v_cndmask_b32 v95, v11, 0, s[100:101]
    s_waitcnt vmcnt(0)
    s_barrier
    s_cmp_eq_u32 s44, 0
    s_cbranch_scc1 Lnocb_29
    s_mov_b32 s62, s60
    v_add_u32 v129, s61, v132
    ds_read_b128 v[104:107], v132
    ds_read_b128 v[108:111], v129
    v_mov_b32 v134, v128
    s_waitcnt lgkmcnt(1)
    v_mfma_f32_32x32x16_bf16 v[16:31], v[104:107], v[100:103], v[80:95]
La1_30:
    s_sub_u32 s62, s62, 1
    s_cmp_eq_u32 s62, 0
    s_cbranch_scc1 Lt0_31
    v_add_u32 v129, s61, v129
    s_waitcnt lgkmcnt(0)
    v_mfma_f32_32x32x16_bf16 v[32:47], v[108:111], v[100:103], 0
    ds_read_b128 v[104:107], v129
    s_nop 4
    v_max3_f32 v128, v16, v17, v128
    v_max3_f32 v128, v18, v19, v128
    v_max3_f32 v128, v20, v21, v128
    v_max3_f32 v128, v22, v23, v128
    v_max3_f32 v128, v24, v25, v128
    v_max3_f32 v128, v26, v27, v128
    v_max3_f32 v128, v28, v29, v128
    v_max3_f32 v128, v30, v31, v128
    s_sub_u32 s62, s62, 1
    s_cmp_eq_u32 s62, 0
    s_cbranch_scc1 Lt1_32
    v_add_u32 v129, s61, v129
    s_waitcnt lgkmcnt(0)
    v_mfma_f32_32x32x16_bf16 v[16:31], v[104:107], v[100:103], 0
    ds_read_b128 v[108:111], v129
    s_nop 4
    v_max3_f32 v128, v32, v33, v128
    v_max3_f32 v128, v34, v35, v128
    v_max3_f32 v128, v36, v37, v128
    v_max3_f32 v128, v38, v39, v128
    v_max3_f32 v128, v40, v41, v128
    v_max3_f32 v128, v42, v43, v128
    v_max3_f32 v128, v44, v45, v128
    v_max3_f32 v128, v46, v47, v128
    s_branch La1_30
Lt0_31:
    s_nop 9
    v_max3_f32 v128, v16, v17, v128
    v_max3_f32 v128, v18, v19, v128
    v_max3_f32 v128, v20, v21, v128
    v_max3_f32 v128, v22, v23, v128
    v_max3_f32 v128, v24, v25, v128
    v_max3_f32 v128, v26, v27, v128
    v_max3_f32 v128, v28, v29, v128
    v_max3_f32 v128, v30, v31, v128
    s_branch Ldn_33
Lt1_32:
    s_nop 9
    v_max3_f32 v128, v32, v33, v128
    v_max3_f32 v128, v34, v35, v128
    v_max3_f32 v128, v36, v37, v128
    v_max3_f32 v128, v38, v39, v128
    v_max3_f32 v128, v40, v41, v128
    v_max3_f32 v128, v42, v43, v128
    v_max3_f32 v128, v44, v45, v128
    v_max3_f32 v128, v46, v47, v128
Ldn_33:
    v_add_u32 v129, s61, v132
    s_waitcnt lgkmcnt(0)
    ds_read_b128 v[104:107], v132
    ds_read_b128 v[108:111], v129
    v_mov_b32 v135, v128
    s_mov_b32 s62, s60
    v_mov_b32 v130, v133
    v_permlane32_swap_b32 v128, v135
    v_max_f32 v128, v128, v135
    v_sub_f32 v80, v80, v128
    v_sub_f32 v81, v81, v128
    v_sub_f32 v82, v82, v128
    v_sub_f32 v83, v83, v128
    v_sub_f32 v84, v84, v128
    v_sub_f32 v85, v85, v128
    v_sub_f32 v86, v86, v128
    v_sub_f32 v87, v87, v128
    v_sub_f32 v88, v88, v128
    v_sub_f32 v89, v89, v128
    v_sub_f32 v90, v90, v128
    v_sub_f32 v91, v91, v128
    v_sub_f32 v92, v92, v128
    v_sub_f32 v93, v93, v128
    v_sub_f32 v94, v94, v128
    v_sub_f32 v95, v95, v128
    v_sub_f32 v134, v134, v128
    v_exp_f32 v134, v134
    v_sub_f32 v64, 0, v128
    v_sub_f32 v65, 0, v128
    v_sub_f32 v66, 0, v128
    v_sub_f32 v67, 0, v128
    v_sub_f32 v68, 0, v128
    v_sub_f32 v69, 0, v128
    v_sub_f32 v70, 0, v128
    v_sub_f32 v71, 0, v128
    v_sub_f32 v72, 0, v128
    v_sub_f32 v73, 0, v128
    v_sub_f32 v74, 0, v128
    v_sub_f32 v75, 0, v128
    v_sub_f32 v76, 0, v128
    v_sub_f32 v77, 0, v128
    v_sub_f32 v78, 0, v128
    v_sub_f32 v79, 0, v128
    v_mul_f32 v48, v134, v48
    v_mul_f32 v49, v134, v49
    v_mul_f32 v50, v134, v50
    v_mul_f32 v51, v134, v51
    v_mul_f32 v52, v134, v52
    v_mul_f32 v53, v134, v53
    v_mul_f32 v54, v134, v54
    v_mul_f32 v55, v134, v55
    v_mul_f32 v56, v134, v56
    s_waitcnt lgkmcnt(1)
    v_mfma_f32_32x32x16_bf16 v[16:31], v[104:107], v[100:103], v[80:95]
La2_34:
    ds_read_b128 v[112:115], v130
    ds_read_b128 v[116:119], v130 offset:1024
    v_add_u32 v129, s61, v129
    s_waitcnt lgkmcnt(2)
    v_mfma_f32_32x32x16_bf16 v[32:47], v[108:111], v[100:103], v[64:79]
    ds_read_b128 v[104:107], v129
    v_add_u32 v130, v131, v130
    s_sub_u32 s62, s62, 1
    s_nop 3
    s_cmp_ge_u32 s54, s53
    s_cbranch_scc1 Lwo_36
    s_mov_b32 m0, s54
    s_nop 0
    buffer_load_dwordx4 v136, s[12:15], s3 offen lds
    s_add_u32 s3, s3, 16384
    s_add_u32 s54, s54, 1024
    s_mov_b32 m0, s54
    s_nop 0
    buffer_load_dwordx4 v136, s[12:15], s3 offen lds
    s_add_u32 s3, s3, 16384
    s_add_u32 s54, s54, 1024
Lwo_36:
    v_exp_f32 v16, v16
    v_exp_f32 v17, v17
    v_exp_f32 v18, v18
    v_exp_f32 v19, v19
    v_exp_f32 v20, v20
    v_exp_f32 v21, v21
    v_exp_f32 v22, v22
    v_exp_f32 v23, v23
    v_exp_f32 v24, v24
    v_exp_f32 v25, v25
    v_exp_f32 v26, v26
    v_exp_f32 v27, v27
    v_exp_f32 v28, v28
    v_exp_f32 v29, v29
    v_exp_f32 v30, v30
    v_exp_f32 v31, v31
    v_cvt_pk_bf16_f32 v120, v16, v17
    v_cvt_pk_bf16_f32 v121, v18, v19
    v_cvt_pk_bf16_f32 v122, v20, v21
    v_cvt_pk_bf16_f32 v123, v22, v23
    v_cvt_pk_bf16_f32 v124, v24, v25
    v_cvt_pk_bf16_f32 v125, v26, v27
    v_cvt_pk_bf16_f32 v126, v28, v29
    v_cvt_pk_bf16_f32 v127, v30, v31
    s_waitcnt lgkmcnt(1)
    s_cmp_eq_u32 s62, 0
    v_mfma_f32_32x32x16_bf16 v[48:63], v[112:115], v[120:123], v[48:63]
    v_mfma_f32_32x32x16_bf16 v[48:63], v[116:119], v[124:127], v[48:63]
    s_cbranch_scc1 Ld2_35
    ds_read_b128 v[112:115], v130
    ds_read_b128 v[116:119], v130 offset:1024
    v_add_u32 v129, s61, v129
    s_waitcnt lgkmcnt(2)
    v_mfma_f32_32x32x16_bf16 v[16:31], v[104:107], v[100:103], v[64:79]
    ds_read_b128 v[108:111], v129
    v_add_u32 v130, v131, v130
    s_sub_u32 s62, s62, 1
    s_nop 3
    s_cmp_ge_u32 s54, s53
    s_cbranch_scc1 Lwo_37
    s_mov_b32 m0, s54
    s_nop 0
    buffer_load_dwordx4 v136, s[12:15], s3 offen lds
    s_add_u32 s3, s3, 16384
    s_add_u32 s54, s54, 1024
    s_mov_b32 m0, s54
    s_nop 0
    buffer_load_dwordx4 v136, s[12:15], s3 offen lds
    s_add_u32 s3, s3, 16384
    s_add_u32 s54, s54, 1024
Lwo_37:
    v_exp_f32 v32, v32
    v_exp_f32 v33, v33
    v_exp_f32 v34, v34
    v_exp_f32 v35, v35
    v_exp_f32 v36, v36
    v_exp_f32 v37, v37
    v_exp_f32 v38, v38
    v_exp_f32 v39, v39
    v_exp_f32 v40, v40
    v_exp_f32 v41, v41
    v_exp_f32 v42, v42
    v_exp_f32 v43, v43
    v_exp_f32 v44, v44
    v_exp_f32 v45, v45
    v_exp_f32 v46, v46
    v_exp_f32 v47, v47
    v_cvt_pk_bf16_f32 v120, v32, v33
    v_cvt_pk_bf16_f32 v121, v34, v35
    v_cvt_pk_bf16_f32 v122, v36, v37
    v_cvt_pk_bf16_f32 v123, v38, v39
    v_cvt_pk_bf16_f32 v124, v40, v41
    v_cvt_pk_bf16_f32 v125, v42, v43
    v_cvt_pk_bf16_f32 v126, v44, v45
    v_cvt_pk_bf16_f32 v127, v46, v47
    s_waitcnt lgkmcnt(1)
    s_cmp_eq_u32 s62, 0
    v_mfma_f32_32x32x16_bf16 v[48:63], v[112:115], v[120:123], v[48:63]
    v_mfma_f32_32x32x16_bf16 v[48:63], v[116:119], v[124:127], v[48:63]
    s_cbranch_scc1 Ld2_35
    s_branch La2_34
Ld2_35:
    s_waitcnt lgkmcnt(0)
    s_branch Lsk_38
Lnocb_29:
    s_mov_b32 m0, s54
    s_nop 0
    buffer_load_dwordx4 v136, s[12:15], s3 offen lds
    s_add_u32 s3, s3, 16384
    s_add_u32 s54, s54, 1024
    s_mov_b32 m0, s54
    s_nop 0
    buffer_load_dwordx4 v136, s[12:15], s3 offen lds
    s_add_u32 s3, s3, 16384
    s_add_u32 s54, s54, 1024
    s_mov_b32 m0, s54
    s_nop 0
    buffer_load_dwordx4 v136, s[12:15], s3 offen lds
    s_add_u32 s3, s3, 16384
    s_add_u32 s54, s54, 1024
    s_mov_b32 m0, s54
    s_nop 0
    buffer_load_dwordx4 v136, s[12:15], s3 offen lds
    s_add_u32 s3, s3, 16384
    s_add_u32 s54, s54, 1024
    s_mov_b32 m0, s54
    s_nop 0
    buffer_load_dwordx4 v136, s[12:15], s3 offen lds
    s_add_u32 s3, s3, 16384
    s_add_u32 s54, s54, 1024
    s_mov_b32 m0, s54
    s_nop 0
    buffer_load_dwordx4 v136, s[12:15], s3 offen lds
    s_add_u32 s3, s3, 16384
    s_add_u32 s54, s54, 1024
    s_mov_b32 m0, s54
    s_nop 0
    buffer_load_dwordx4 v136, s[12:15], s3 offen lds
    s_add_u32 s3, s3, 16384
    s_add_u32 s54, s54, 1024
    s_mov_b32 m0, s54
    s_nop 0
    buffer_load_dwordx4 v136, s[12:15], s3 offen lds
    s_add_u32 s3, s3, 16384
    s_add_u32 s54, s54, 1024
Lsk_38:
    s_lshl_b32 s48, s44, 2
    s_add_u32 s48, s48, s87
    s_lshl_b32 s48, s48, 5
    s_lshl_b32 s49, s45, 1
    s_add_u32 s48, s48, s49
    s_add_u32 s48, s48, s86
    s_lshl_b32 s48, s48, 10
    s_add_u32 s48, s48, 4259840
    s_nop 3
    v_rcp_f32 v134, v56
    s_nop 0
    v_mul_f32 v48, v134, v48
    v_mul_f32 v49, v134, v49
    v_mul_f32 v50, v134, v50
    v_mul_f32 v51, v134, v51
    v_mul_f32 v52, v134, v52
    v_mul_f32 v53, v134, v53
    v_mul_f32 v54, v134, v54
    v_mul_f32 v55, v134, v55
    v_cvt_pk_bf16_f32 v120, v48, v49
    v_cvt_pk_bf16_f32 v121, v50, v51
    v_cvt_pk_bf16_f32 v122, v52, v53
    v_cvt_pk_bf16_f32 v123, v54, v55
    buffer_store_dwordx4 v[120:123], v15, s[40:43], s48 offen sc1
    s_waitcnt vmcnt(0)
    s_barrier
    s_cmp_lg_u32 s46, 0
    s_cbranch_scc1 Lsf_39
    s_lshl_b32 s48, s44, 10
    s_lshl_b32 s49, s45, 6
    s_add_u32 s48, s48, s49
    s_add_u32 s48, s48, 16384
    v_mov_b32 v250, s47
    v_lshl_add_u32 v251, v1, 2, s48
    s_mov_b64 exec, 0xffff
    buffer_store_dword v250, v251, s[40:43], 0 offen sc1
    s_mov_b64 exec, -1
    Lsf_39:
    s_cmp_eq_u32 s46, 0
    s_cbranch_scc1 Lw1b_40
    s_and_b32 s48, s45, 1
    s_lshl_b32 s48, s48, 2
    s_and_b32 s49, s46, 1
    s_lshl_b32 s49, s49, 1
    s_add_u32 s48, s48, s49
    s_add_u32 s97, s48, s86
    s_lshl_b32 s48, s44, 3
    s_add_u32 s48, s48, s97
    s_lshl_b32 s48, s48, 14
    s_lshr_b32 s49, s45, 1
    s_lshl_b32 s49, s49, 7
    s_add_u32 s48, s48, s49
    s_bfe_u32 s55, s46, 0x10001
    s_lshl_b32 s55, s55, 6
    s_add_u32 s48, s48, s55
    v_and_b32 v244, 15, v1
    v_lshlrev_b32 v244, 10, v244
    v_lshrrev_b32 v12, 4, v1
    v_lshl_add_u32 v244, v12, 3, v244
    v_add_u32 v244, s48, v244
    buffer_load_dwordx2 v[236:237], v244, s[4:7], 0 offen
    buffer_load_dwordx2 v[238:239], v244, s[4:7], 0 offen offset:32
    s_sub_u32 s57, s46, 1
Lw1l_41:
    s_lshl_b32 s56, s57, 6
    v_add_u32 v240, s56, v1
    v_mul_u32_u24 v241, s63, v240
    v_lshlrev_b32 v240, 4, v240
    v_lshrrev_b32 v241, 20, v241
    s_lshl_b32 s56, s57, 10
    v_mad_u32_u24 v240, v241, v243, v240
    s_mov_b32 m0, s56
    s_nop 0
    buffer_load_dwordx4 v240, s[16:19], s59 offen lds
    s_add_u32 s57, s57, 7
    s_cmp_lt_u32 s57, 96
    s_cbranch_scc1 Lw1l_41
Lw1b_40:
    s_and_b32 s88, s46, 1
    s_lshr_b32 s89, s46, 1
    s_and_b32 s90, s89, 1
    v_lshrrev_b32 v10, 5, v1
    v_bfe_u32 v11, v1, 2, 2
    v_lshl_add_u32 v10, v10, 2, v11
    v_lshlrev_b32 v10, 6, v10
    v_bfe_u32 v11, v1, 4, 1
    v_lshl_add_u32 v10, v11, 5, v10
    v_and_b32 v11, 3, v1
    v_lshl_add_u32 v10, v11, 3, v10
    s_lshl_b32 s48, s89, 13
    s_add_u32 s48, s48, 98304
    v_add_u32 v10, s48, v10
    ds_read_b64_tr_b16 v[80:81], v10 offset:0
    ds_read_b64_tr_b16 v[82:83], v10 offset:512
    ds_read_b64_tr_b16 v[84:85], v10 offset:32768
    ds_read_b64_tr_b16 v[86:87], v10 offset:33280
    ds_read_b64_tr_b16 v[88:89], v10 offset:1024
    ds_read_b64_tr_b16 v[90:91], v10 offset:1536
    ds_read_b64_tr_b16 v[92:93], v10 offset:33792
    ds_read_b64_tr_b16 v[94:95], v10 offset:34304
    ds_read_b64_tr_b16 v[96:97], v10 offset:2048
    ds_read_b64_tr_b16 v[98:99], v10 offset:2560
    ds_read_b64_tr_b16 v[100:101], v10 offset:34816
    ds_read_b64_tr_b16 v[102:103], v10 offset:35328
    ds_read_b64_tr_b16 v[104:105], v10 offset:3072
    ds_read_b64_tr_b16 v[106:107], v10 offset:3584
    ds_read_b64_tr_b16 v[108:109], v10 offset:35840
    ds_read_b64_tr_b16 v[110:111], v10 offset:36352
    ds_read_b64_tr_b16 v[112:113], v10 offset:4096
    ds_read_b64_tr_b16 v[114:115], v10 offset:4608
    ds_read_b64_tr_b16 v[116:117], v10 offset:36864
    ds_read_b64_tr_b16 v[118:119], v10 offset:37376
    ds_read_b64_tr_b16 v[120:121], v10 offset:5120
    ds_read_b64_tr_b16 v[122:123], v10 offset:5632
    ds_read_b64_tr_b16 v[124:125], v10 offset:37888
    ds_read_b64_tr_b16 v[126:127], v10 offset:38400
    ds_read_b64_tr_b16 v[128:129], v10 offset:6144
    ds_read_b64_tr_b16 v[130:131], v10 offset:6656
    ds_read_b64_tr_b16 v[132:133], v10 offset:38912
    ds_read_b64_tr_b16 v[134:135], v10 offset:39424
    ds_read_b64_tr_b16 v[136:137], v10 offset:7168
    ds_read_b64_tr_b16 v[138:139], v10 offset:7680
    ds_read_b64_tr_b16 v[140:141], v10 offset:39936
    ds_read_b64_tr_b16 v[142:143], v10 offset:40448
    s_and_b32 s48, s45, 1
    s_lshl_b32 s48, s48, 1
    s_add_u32 s48, s48, s88
    s_lshl_b32 s49, s44, 2
    s_add_u32 s48, s48, s49
    s_lshl_b32 s48, s48, 15
    s_lshl_b32 s49, s89, 13
    s_add_u32 s48, s48, s49
    s_add_u32 s91, s48, 4259840
    s_add_u32 s92, s91, 4096
    s_cmp_lg_u32 s46, 0
    s_cbranch_scc1 Lpl_42
    s_mov_b32 s48, 0
    s_lshl_b32 s49, s44, 10
    s_add_u32 s49, s49, 16384
    v_lshl_add_u32 v251, v1, 6, s49
    s_mov_b64 exec, 0xffff
    buffer_load_dword v248, v251, s[40:43], 0 offen sc1
    buffer_load_dword v247, v251, s[40:43], 0 offen sc1
    buffer_load_dword v246, v251, s[40:43], 0 offen sc1
Lpp_43:
    buffer_load_dword v250, v251, s[40:43], 0 offen sc1
    s_waitcnt vmcnt(3)
    v_cmp_ne_u32 vcc, s47, v248
    s_cmp_eq_u64 vcc, 0
    s_cbranch_scc1 Lpd_44
    buffer_load_dword v248, v251, s[40:43], 0 offen sc1
    s_waitcnt vmcnt(3)
    v_cmp_ne_u32 vcc, s47, v247
    s_cmp_eq_u64 vcc, 0
    s_cbranch_scc1 Lpd_44
    buffer_load_dword v247, v251, s[40:43], 0 offen sc1
    s_waitcnt vmcnt(3)
    v_cmp_ne_u32 vcc, s47, v246
    s_cmp_eq_u64 vcc, 0
    s_cbranch_scc1 Lpd_44
    buffer_load_dword v246, v251, s[40:43], 0 offen sc1
    s_waitcnt vmcnt(3)
    v_cmp_ne_u32 vcc, s47, v250
    s_cmp_eq_u64 vcc, 0
    s_cbranch_scc1 Lpd_44
    s_add_u32 s48, s48, 1
    s_cmp_lt_u32 s48, 400000
    s_cbranch_scc1 Lpp_43
    Lpd_44:
    s_mov_b64 exec, -1
Lpl_42:
    s_waitcnt lgkmcnt(0)
    s_barrier
    s_cmp_lg_u32 s46, 0
    s_cbranch_scc1 Lsl0_45
    s_and_b32 s48, s45, 1
    s_lshl_b32 s48, s48, 2
    s_and_b32 s49, s46, 1
    s_lshl_b32 s49, s49, 1
    s_add_u32 s48, s48, s49
    s_add_u32 s97, s48, s86
    s_lshl_b32 s48, s44, 3
    s_add_u32 s48, s48, s97
    s_lshl_b32 s48, s48, 14
    s_lshr_b32 s49, s45, 1
    s_lshl_b32 s49, s49, 7
    s_add_u32 s48, s48, s49
    s_bfe_u32 s55, s46, 0x10001
    s_lshl_b32 s55, s55, 6
    s_add_u32 s48, s48, s55
    v_and_b32 v244, 15, v1
    v_lshlrev_b32 v244, 10, v244
    v_lshrrev_b32 v12, 4, v1
    v_lshl_add_u32 v244, v12, 3, v244
    v_add_u32 v244, s48, v244
    buffer_load_dwordx2 v[236:237], v244, s[4:7], 0 offen
    buffer_load_dwordx2 v[238:239], v244, s[4:7], 0 offen offset:32
Lsl0_45:
    buffer_load_dwordx4 v[48:51], v15, s[40:43], s91 offen offset:0 sc1
    buffer_load_dwordx4 v[52:55], v15, s[40:43], s91 offen offset:1024 sc1
    buffer_load_dwordx4 v[56:59], v15, s[40:43], s91 offen offset:2048 sc1
    buffer_load_dwordx4 v[60:63], v15, s[40:43], s91 offen offset:3072 sc1
    buffer_load_dwordx4 v[64:67], v15, s[40:43], s92 offen offset:0 sc1
    buffer_load_dwordx4 v[68:71], v15, s[40:43], s92 offen offset:1024 sc1
    buffer_load_dwordx4 v[72:75], v15, s[40:43], s92 offen offset:2048 sc1
    buffer_load_dwordx4 v[76:79], v15, s[40:43], s92 offen offset:3072 sc1
    s_waitcnt vmcnt(7)
    v_mfma_f32_32x32x16_bf16 v[16:31], v[80:83], v[48:51], 0
    v_mfma_f32_32x32x16_bf16 v[32:47], v[84:87], v[48:51], 0
    s_waitcnt vmcnt(6)
    v_mfma_f32_32x32x16_bf16 v[16:31], v[88:91], v[52:55], v[16:31]
    v_mfma_f32_32x32x16_bf16 v[32:47], v[92:95], v[52:55], v[32:47]
    s_waitcnt vmcnt(5)
    v_mfma_f32_32x32x16_bf16 v[16:31], v[96:99], v[56:59], v[16:31]
    v_mfma_f32_32x32x16_bf16 v[32:47], v[100:103], v[56:59], v[32:47]
    s_waitcnt vmcnt(4)
    v_mfma_f32_32x32x16_bf16 v[16:31], v[104:107], v[60:63], v[16:31]
    v_mfma_f32_32x32x16_bf16 v[32:47], v[108:111], v[60:63], v[32:47]
    s_waitcnt vmcnt(3)
    v_mfma_f32_32x32x16_bf16 v[16:31], v[112:115], v[64:67], v[16:31]
    v_mfma_f32_32x32x16_bf16 v[32:47], v[116:119], v[64:67], v[32:47]
    s_waitcnt vmcnt(2)
    v_mfma_f32_32x32x16_bf16 v[16:31], v[120:123], v[68:71], v[16:31]
    v_mfma_f32_32x32x16_bf16 v[32:47], v[124:127], v[68:71], v[32:47]
    s_waitcnt vmcnt(1)
    v_mfma_f32_32x32x16_bf16 v[16:31], v[128:131], v[72:75], v[16:31]
    v_mfma_f32_32x32x16_bf16 v[32:47], v[132:135], v[72:75], v[32:47]
    s_waitcnt vmcnt(0)
    v_mfma_f32_32x32x16_bf16 v[16:31], v[136:139], v[76:79], v[16:31]
    v_mfma_f32_32x32x16_bf16 v[32:47], v[140:143], v[76:79], v[32:47]
    v_and_b32 v10, 15, v1
    v_bfe_u32 v11, v1, 4, 1
    v_lshl_add_u32 v10, v11, 5, v10
    v_lshlrev_b32 v10, 4, v10
    v_lshrrev_b32 v11, 5, v1
    v_lshl_add_u32 v10, v11, 10, v10
    s_lshl_b32 s48, s88, 13
    s_lshl_b32 s49, s90, 12
    s_add_u32 s48, s48, s49
    s_lshl_b32 s49, s86, 8
    s_add_u32 s48, s48, s49
    s_add_u32 s48, s48, 98304
    v_add_u32 v13, s48, v10
    s_lshl_b32 s48, s46, 13
    s_add_u32 s48, s48, 98304
    v_add_u32 v12, s48, v15
    ds_write_b128 v12, v[16:19] offset:0
    ds_write_b128 v12, v[20:23] offset:1024
    ds_write_b128 v12, v[24:27] offset:2048
    ds_write_b128 v12, v[28:31] offset:3072
    ds_write_b128 v12, v[32:35] offset:4096
    ds_write_b128 v12, v[36:39] offset:5120
    ds_write_b128 v12, v[40:43] offset:6144
    ds_write_b128 v12, v[44:47] offset:7168
    s_waitcnt lgkmcnt(0)
    s_barrier
    ds_read_b128 v[48:51], v13 offset:0
    ds_read_b128 v[52:55], v13 offset:2048
    ds_read_b128 v[56:59], v13 offset:16384
    ds_read_b128 v[60:63], v13 offset:18432
    ds_read_b128 v[64:67], v13 offset:32768
    ds_read_b128 v[68:71], v13 offset:34816
    ds_read_b128 v[72:75], v13 offset:49152
    ds_read_b128 v[76:79], v13 offset:51200
    s_waitcnt lgkmcnt(4)
    v_add_f32 v48, v48, v56
    v_add_f32 v49, v49, v57
    v_add_f32 v50, v50, v58
    v_add_f32 v51, v51, v59
    v_add_f32 v52, v52, v60
    v_add_f32 v53, v53, v61
    v_add_f32 v54, v54, v62
    v_add_f32 v55, v55, v63
    s_waitcnt lgkmcnt(2)
    v_add_f32 v48, v48, v64
    v_add_f32 v49, v49, v65
    v_add_f32 v50, v50, v66
    v_add_f32 v51, v51, v67
    v_add_f32 v52, v52, v68
    v_add_f32 v53, v53, v69
    v_add_f32 v54, v54, v70
    v_add_f32 v55, v55, v71
    s_waitcnt lgkmcnt(0)
    v_add_f32 v48, v48, v72
    v_add_f32 v49, v49, v73
    v_add_f32 v50, v50, v74
    v_add_f32 v51, v51, v75
    v_add_f32 v52, v52, v76
    v_add_f32 v53, v53, v77
    v_add_f32 v54, v54, v78
    v_add_f32 v55, v55, v79
    s_barrier
    s_lshl_b32 s57, s46, 1
    s_add_u32 s57, s57, 96
    s_lshl_b32 s56, s57, 6
    v_add_u32 v240, s56, v1
    v_mul_u32_u24 v241, s63, v240
    v_lshlrev_b32 v240, 4, v240
    v_lshrrev_b32 v241, 20, v241
    s_lshl_b32 s56, s57, 10
    v_mad_u32_u24 v240, v241, v243, v240
    s_mov_b32 m0, s56
    s_nop 0
    buffer_load_dwordx4 v240, s[16:19], s59 offen lds
    s_add_u32 s57, s57, 1
    s_lshl_b32 s56, s57, 6
    v_add_u32 v240, s56, v1
    v_mul_u32_u24 v241, s63, v240
    v_lshlrev_b32 v240, 4, v240
    v_lshrrev_b32 v241, 20, v241
    s_lshl_b32 s56, s57, 10
    v_mad_u32_u24 v240, v241, v243, v240
    s_mov_b32 m0, s56
    s_nop 0
    buffer_load_dwordx4 v240, s[16:19], s59 offen lds
    v_lshlrev_b32 v64, 16, v236
    v_and_b32 v65, 0xffff0000, v236
    v_lshlrev_b32 v66, 16, v237
    v_and_b32 v67, 0xffff0000, v237
    v_lshlrev_b32 v68, 16, v238
    v_and_b32 v69, 0xffff0000, v238
    v_lshlrev_b32 v70, 16, v239
    v_and_b32 v71, 0xffff0000, v239
    v_add_f32 v48, v48, v64
    v_add_f32 v49, v49, v65
    v_add_f32 v50, v50, v66
    v_add_f32 v51, v51, v67
    v_add_f32 v52, v52, v68
    v_add_f32 v53, v53, v69
    v_add_f32 v54, v54, v70
    v_add_f32 v55, v55, v71
    v_cvt_pk_bf16_f32 v56, v48, v49
    v_cvt_pk_bf16_f32 v57, v50, v51
    v_cvt_pk_bf16_f32 v58, v52, v53
    v_cvt_pk_bf16_f32 v59, v54, v55
    s_lshl_b32 s48, s44, 3
    s_add_u32 s48, s48, s97
    s_lshl_b32 s93, s48, 4
    s_and_b32 s49, s45, 14
    s_add_u32 s49, s49, s90
    s_add_u32 s55, s93, s49
    s_lshl_b32 s55, s55, 10
    s_add_u32 s55, s55, 6356992
    buffer_store_dwordx4 v[56:59], v15, s[40:43], s55 offen sc1
    v_lshlrev_b32 v228, 16, v56
    v_and_b32 v229, 0xffff0000, v56
    v_lshlrev_b32 v230, 16, v57
    v_and_b32 v231, 0xffff0000, v57
    v_lshlrev_b32 v232, 16, v58
    v_and_b32 v233, 0xffff0000, v58
    v_lshlrev_b32 v234, 16, v59
    v_and_b32 v235, 0xffff0000, v59
    v_add_f32 v60, v228, v229
    v_mul_f32 v61, v228, v228
    v_fma_f32 v61, v229, v229, v61
    v_add_f32 v60, v60, v230
    v_fma_f32 v61, v230, v230, v61
    v_add_f32 v60, v60, v231
    v_fma_f32 v61, v231, v231, v61
    v_add_f32 v60, v60, v232
    v_fma_f32 v61, v232, v232, v61
    v_add_f32 v60, v60, v233
    v_fma_f32 v61, v233, v233, v61
    v_add_f32 v60, v60, v234
    v_fma_f32 v61, v234, v234, v61
    v_add_f32 v60, v60, v235
    v_fma_f32 v61, v235, v235, v61
    v_mov_b32 v62, v60
    s_nop 1
    v_permlane16_swap_b32 v60, v62
    v_add_f32 v60, v60, v62
    v_mov_b32 v62, v60
    s_nop 1
    v_permlane32_swap_b32 v60, v62
    v_add_f32 v60, v60, v62
    v_mov_b32 v63, v61
    s_nop 1
    v_permlane16_swap_b32 v61, v63
    v_add_f32 v61, v61, v63
    v_mov_b32 v63, v61
    s_nop 1
    v_permlane32_swap_b32 v61, v63
    v_add_f32 v61, v61, v63
    s_lshl_b32 s48, s93, 7
    s_lshl_b32 s49, s49, 7
    s_add_u32 s48, s48, s49
    s_add_u32 s48, s48, 8454144
    v_lshlrev_b32 v10, 3, v1
    s_mov_b64 exec, 0xffff
    buffer_store_dwordx2 v[60:61], v10, s[40:43], s48 offen sc1
    s_mov_b64 exec, -1
    s_lshr_b32 s49, s45, 1
    s_lshl_b32 s49, s49, 7
    s_bfe_u32 s55, s46, 0x10001
    s_lshl_b32 s55, s55, 6
    v_lshrrev_b32 v12, 4, v1
    s_add_u32 s48, s49, s55
    v_lshlrev_b32 v12, 3, v12
    buffer_load_dwordx2 v[224:225], v12, s[28:31], s48 offen
    buffer_load_dwordx2 v[226:227], v12, s[28:31], s48 offen offset:32
    s_and_b32 s48, s45, 1
    s_cselect_b32 s49, 0, 192
    s_lshl_b32 s48, s48, 5
    v_add_u32 v13, s48, v12
    v_add_u32 v12, s49, v12
    buffer_load_dwordx2 v[206:207], v13, s[24:27], s59 offen
    buffer_load_dwordx2 v[208:209], v13, s[24:27], s59 offen offset:32
    buffer_load_dwordx2 v[210:211], v13, s[24:27], s59 offen offset:64
    buffer_load_dwordx2 v[212:213], v13, s[24:27], s59 offen offset:96
    buffer_load_dwordx2 v[214:215], v13, s[24:27], s59 offen offset:128
    buffer_load_dwordx2 v[216:217], v13, s[24:27], s59 offen offset:160
    buffer_load_dwordx2 v[218:219], v12, s[24:27], s59 offen
    s_waitcnt vmcnt(9)
    s_barrier
    s_cmp_lg_u32 s46, 0
    s_cbranch_scc1 Lsf_46
    s_lshl_b32 s48, s44, 10
    s_lshl_b32 s49, s45, 6
    s_add_u32 s48, s48, s49
    s_add_u32 s48, s48, 32768
    v_mov_b32 v250, s47
    v_lshl_add_u32 v251, v1, 2, s48
    s_mov_b64 exec, 0xffff
    buffer_store_dword v250, v251, s[40:43], 0 offen sc1
    s_mov_b64 exec, -1
    Lsf_46:
    s_and_b32 s94, s45, 1
    s_lshl_b32 s48, s94, 5
    s_cmp_eq_u32 s94, 0
    s_cselect_b32 s49, 192, 0
    v_lshrrev_b32 v13, 2, v1
    v_mul_u32_u24 v13, 224, v13
    v_and_b32 v12, 3, v1
    v_lshl_add_u32 v14, v12, 3, v13
    v_add_u32 v10, s48, v14
    v_add_u32 v11, s49, v14
    s_mul_i32 s55, s86, 57344
    v_add_u32 v10, s55, v10
    v_add_u32 v11, s55, v11
    v_lshrrev_b32 v2, 4, v1
    v_lshlrev_b32 v3, 3, v2
    v_add_u32 v4, s48, v3
    v_add_u32 v5, s49, v3
    s_cmp_eq_u32 s46, 7
    s_cbranch_scc1 Lcs3_47
    s_lshl_b32 s55, s46, 5
    v_add_u32 v6, s55, v14
    v_add_u32 v7, 57344, v6
    v_mov_b32 v20, s58
    v_mov_b32 v21, s58
    v_mov_b32 v22, s58
    v_mov_b32 v23, s58
    ds_read_b64_tr_b16 v[150:151], v6 offset:0
    ds_read_b64_tr_b16 v[152:153], v6 offset:3584
    ds_read_b64_tr_b16 v[154:155], v6 offset:7168
    ds_read_b64_tr_b16 v[156:157], v6 offset:10752
    ds_read_b64_tr_b16 v[158:159], v6 offset:14336
    ds_read_b64_tr_b16 v[160:161], v6 offset:17920
    ds_read_b64_tr_b16 v[162:163], v6 offset:21504
    ds_read_b64_tr_b16 v[164:165], v6 offset:25088
    ds_read_b64_tr_b16 v[166:167], v6 offset:28672
    ds_read_b64_tr_b16 v[168:169], v6 offset:32256
    ds_read_b64_tr_b16 v[170:171], v6 offset:35840
    ds_read_b64_tr_b16 v[172:173], v6 offset:39424
    ds_read_b64_tr_b16 v[174:175], v6 offset:43008
    ds_read_b64_tr_b16 v[176:177], v6 offset:46592
    ds_read_b64_tr_b16 v[178:179], v6 offset:50176
    ds_read_b64_tr_b16 v[180:181], v6 offset:53760
    s_waitcnt lgkmcnt(14)
    v_mfma_f32_16x16x32_bf16 v[16:19], v[150:153], v[20:23], 0
    s_waitcnt lgkmcnt(12)
    v_mfma_f32_16x16x32_bf16 v[16:19], v[154:157], v[20:23], v[16:19]
    s_waitcnt lgkmcnt(10)
    v_mfma_f32_16x16x32_bf16 v[16:19], v[158:161], v[20:23], v[16:19]
    s_waitcnt lgkmcnt(8)
    v_mfma_f32_16x16x32_bf16 v[16:19], v[162:165], v[20:23], v[16:19]
    s_waitcnt lgkmcnt(6)
    v_mfma_f32_16x16x32_bf16 v[16:19], v[166:169], v[20:23], v[16:19]
    s_waitcnt lgkmcnt(4)
    v_mfma_f32_16x16x32_bf16 v[16:19], v[170:173], v[20:23], v[16:19]
    s_waitcnt lgkmcnt(2)
    v_mfma_f32_16x16x32_bf16 v[16:19], v[174:177], v[20:23], v[16:19]
    s_waitcnt lgkmcnt(0)
    v_mfma_f32_16x16x32_bf16 v[16:19], v[178:181], v[20:23], v[16:19]
    ds_read_b64_tr_b16 v[150:151], v7 offset:0
    ds_read_b64_tr_b16 v[152:153], v7 offset:3584
    ds_read_b64_tr_b16 v[154:155], v7 offset:7168
    ds_read_b64_tr_b16 v[156:157], v7 offset:10752
    ds_read_b64_tr_b16 v[158:159], v7 offset:14336
    ds_read_b64_tr_b16 v[160:161], v7 offset:17920
    ds_read_b64_tr_b16 v[162:163], v7 offset:21504
    ds_read_b64_tr_b16 v[164:165], v7 offset:25088
    ds_read_b64_tr_b16 v[166:167], v7 offset:28672
    ds_read_b64_tr_b16 v[168:169], v7 offset:32256
    ds_read_b64_tr_b16 v[170:171], v7 offset:35840
    ds_read_b64_tr_b16 v[172:173], v7 offset:39424
    ds_read_b64_tr_b16 v[174:175], v7 offset:43008
    ds_read_b64_tr_b16 v[176:177], v7 offset:46592
    ds_read_b64_tr_b16 v[178:179], v7 offset:50176
    ds_read_b64_tr_b16 v[180:181], v7 offset:53760
    s_waitcnt lgkmcnt(14)
    v_mfma_f32_16x16x32_bf16 v[16:19], v[150:153], v[20:23], v[16:19]
    s_waitcnt lgkmcnt(12)
    v_mfma_f32_16x16x32_bf16 v[16:19], v[154:157], v[20:23], v[16:19]
    s_waitcnt lgkmcnt(10)
    v_mfma_f32_16x16x32_bf16 v[16:19], v[158:161], v[20:23], v[16:19]
    s_waitcnt lgkmcnt(8)
    v_mfma_f32_16x16x32_bf16 v[16:19], v[162:165], v[20:23], v[16:19]
    s_waitcnt lgkmcnt(6)
    v_mfma_f32_16x16x32_bf16 v[16:19], v[166:169], v[20:23], v[16:19]
    s_waitcnt lgkmcnt(4)
    v_mfma_f32_16x16x32_bf16 v[16:19], v[170:173], v[20:23], v[16:19]
    s_waitcnt lgkmcnt(2)
    v_mfma_f32_16x16x32_bf16 v[16:19], v[174:177], v[20:23], v[16:19]
    s_waitcnt lgkmcnt(0)
    v_mfma_f32_16x16x32_bf16 v[16:19], v[178:181], v[20:23], v[16:19]
    s_lshl_b32 s55, s46, 6
    v_lshl_add_u32 v6, v2, 4, s55
    v_add_u32 v6, 114688, v6
    s_nop 5
    ds_write_b128 v6, v[16:19]
    Lcs3_47:
    v_lshlrev_b32 v6, 1, v4
    v_lshlrev_b32 v7, 1, v5
    v_add_u32 v6, 114688, v6
    v_add_u32 v7, 114688, v7
    s_waitcnt lgkmcnt(0)
    s_barrier
    ds_read_b128 v[178:181], v6 offset:0
    ds_read_b128 v[182:185], v6 offset:64
    ds_read_b128 v[186:189], v6 offset:128
    ds_read_b128 v[190:193], v6 offset:192
    ds_read_b128 v[194:197], v6 offset:256
    ds_read_b128 v[198:201], v6 offset:320
    ds_read_b128 v[202:205], v7
    s_lshl_b32 s48, s44, 2
    s_add_u32 s48, s48, s50
    s_lshl_b32 s48, s48, 1
    s_add_u32 s95, s48, s86
    s_lshl_b32 s68, s95, 11
    s_add_u32 s68, s68, 8454144
    s_lshl_b32 s49, s86, 13
    s_add_u32 s49, s49, 6356992
    s_lshl_b32 s64, s95, 14
    s_add_u32 s64, s64, s49
    s_add_u32 s65, s64, 4096
    s_xor_b32 s66, s95, 1
    s_lshl_b32 s66, s66, 14
    s_add_u32 s66, s66, s49
    s_add_u32 s67, s66, 4096
    v_and_b32 v14, 15, v1
    v_lshlrev_b32 v14, 3, v14
    v_lshl_add_u32 v14, v2, 9, v14
    s_cmp_lg_u32 s46, 0
    s_cbranch_scc1 Lpl_48
    s_mov_b32 s48, 0
    s_lshl_b32 s49, s44, 10
    s_add_u32 s49, s49, 32768
    v_lshl_add_u32 v251, v1, 6, s49
    s_mov_b64 exec, 0xffff
    buffer_load_dword v248, v251, s[40:43], 0 offen sc1
    buffer_load_dword v247, v251, s[40:43], 0 offen sc1
    buffer_load_dword v246, v251, s[40:43], 0 offen sc1
Lpp_49:
    buffer_load_dword v250, v251, s[40:43], 0 offen sc1
    s_waitcnt vmcnt(3)
    v_cmp_ne_u32 vcc, s47, v248
    s_cmp_eq_u64 vcc, 0
    s_cbranch_scc1 Lpd_50
    buffer_load_dword v248, v251, s[40:43], 0 offen sc1
    s_waitcnt vmcnt(3)
    v_cmp_ne_u32 vcc, s47, v247
    s_cmp_eq_u64 vcc, 0
    s_cbranch_scc1 Lpd_50
    buffer_load_dword v247, v251, s[40:43], 0 offen sc1
    s_waitcnt vmcnt(3)
    v_cmp_ne_u32 vcc, s47, v246
    s_cmp_eq_u64 vcc, 0
    s_cbranch_scc1 Lpd_50
    buffer_load_dword v246, v251, s[40:43], 0 offen sc1
    s_waitcnt vmcnt(3)
    v_cmp_ne_u32 vcc, s47, v250
    s_cmp_eq_u64 vcc, 0
    s_cbranch_scc1 Lpd_50
    s_add_u32 s48, s48, 1
    s_cmp_lt_u32 s48, 400000
    s_cbranch_scc1 Lpp_49
    Lpd_50:
    s_mov_b64 exec, -1
Lpl_48:
    s_waitcnt lgkmcnt(0)
    s_barrier
    buffer_load_dwordx2 v[2:3], v14, s[40:43], s68 offen offset:0 sc1
    buffer_load_dwordx2 v[4:5], v14, s[40:43], s68 offen offset:128 sc1
    buffer_load_dwordx2 v[6:7], v14, s[40:43], s68 offen offset:256 sc1
    buffer_load_dwordx2 v[8:9], v14, s[40:43], s68 offen offset:384 sc1
    buffer_load_dwordx4 v[72:75], v15, s[40:43], s64 offen offset:0 sc1
    buffer_load_dwordx4 v[76:79], v15, s[40:43], s66 offen offset:0 sc1
    buffer_load_dwordx4 v[80:83], v15, s[40:43], s64 offen offset:1024 sc1
    buffer_load_dwordx4 v[84:87], v15, s[40:43], s66 offen offset:1024 sc1
    buffer_load_dwordx4 v[88:91], v15, s[40:43], s64 offen offset:2048 sc1
    buffer_load_dwordx4 v[92:95], v15, s[40:43], s66 offen offset:2048 sc1
    v_lshrrev_b32 v220, 3, v1
    v_lshlrev_b32 v220, 10, v220
    v_bfe_u32 v221, v1, 1, 2
    v_lshrrev_b32 v222, 4, v1
    v_xor_b32 v221, v221, v222
    v_lshl_add_u32 v220, v221, 5, v220
    v_and_b32 v221, 1, v1
    v_lshl_add_u32 v220, v221, 4, v220
    s_lshr_b32 s48, s45, 1
    s_lshl_b32 s48, s48, 7
    v_add_u32 v245, s48, v220
    s_mul_i32 s69, s89, 458752
    s_lshl_b32 s48, s88, 14
    s_add_u32 s69, s69, s48
    s_lshl_b32 s48, s88, 11
    s_mul_i32 s70, s89, 12288
    s_add_u32 s70, s70, s48
    s_add_u32 s70, s70, 114688
    s_mul_i32 s71, s89, 28672
    s_add_u32 s71, s71, s48
    ds_read_b64_tr_b16 v[150:151], v10 offset:0
    ds_read_b64_tr_b16 v[152:153], v10 offset:3584
    ds_read_b64_tr_b16 v[154:155], v10 offset:32
    ds_read_b64_tr_b16 v[156:157], v10 offset:3616
    ds_read_b64_tr_b16 v[158:159], v10 offset:64
    ds_read_b64_tr_b16 v[160:161], v10 offset:3648
    ds_read_b64_tr_b16 v[162:163], v10 offset:96
    ds_read_b64_tr_b16 v[164:165], v10 offset:3680
    ds_read_b64_tr_b16 v[166:167], v10 offset:128
    ds_read_b64_tr_b16 v[168:169], v10 offset:3712
    ds_read_b64_tr_b16 v[170:171], v10 offset:160
    ds_read_b64_tr_b16 v[172:173], v10 offset:3744
    ds_read_b64_tr_b16 v[174:175], v11 offset:0
    ds_read_b64_tr_b16 v[176:177], v11 offset:3584
    s_waitcnt vmcnt(4) lgkmcnt(12)
    v_mfma_f32_16x16x32_bf16 v[16:19], v[150:153], v[72:75], 0
    v_mfma_f32_16x16x32_bf16 v[44:47], v[150:153], v[76:79], 0
    ds_read_b64_tr_b16 v[150:151], v10 offset:7168
    ds_read_b64_tr_b16 v[152:153], v10 offset:10752
    buffer_load_dwordx4 v[96:99], v15, s[40:43], s64 offen offset:3072 sc1
    buffer_load_dwordx4 v[100:103], v15, s[40:43], s66 offen offset:3072 sc1
    s_waitcnt lgkmcnt(12)
    v_mfma_f32_16x16x32_bf16 v[20:23], v[154:157], v[72:75], 0
    v_mfma_f32_16x16x32_bf16 v[48:51], v[154:157], v[76:79], 0
    ds_read_b64_tr_b16 v[154:155], v10 offset:7200
    ds_read_b64_tr_b16 v[156:157], v10 offset:10784
    s_waitcnt lgkmcnt(12)
    v_mfma_f32_16x16x32_bf16 v[24:27], v[158:161], v[72:75], 0
    v_mfma_f32_16x16x32_bf16 v[52:55], v[158:161], v[76:79], 0
    ds_read_b64_tr_b16 v[158:159], v10 offset:7232
    ds_read_b64_tr_b16 v[160:161], v10 offset:10816
    s_waitcnt lgkmcnt(12)
    v_mfma_f32_16x16x32_bf16 v[28:31], v[162:165], v[72:75], 0
    v_mfma_f32_16x16x32_bf16 v[56:59], v[162:165], v[76:79], 0
    ds_read_b64_tr_b16 v[162:163], v10 offset:7264
    ds_read_b64_tr_b16 v[164:165], v10 offset:10848
    s_add_u32 s48, s69, 0
    s_add_u32 s49, s70, 0
    s_mov_b32 m0, s49
    s_nop 0
    buffer_load_dwordx4 v245, s[20:23], s48 offen lds
    s_waitcnt lgkmcnt(12)
    v_mfma_f32_16x16x32_bf16 v[32:35], v[166:169], v[72:75], 0
    v_mfma_f32_16x16x32_bf16 v[60:63], v[166:169], v[76:79], 0
    ds_read_b64_tr_b16 v[166:167], v10 offset:7296
    ds_read_b64_tr_b16 v[168:169], v10 offset:10880
    s_waitcnt lgkmcnt(12)
    v_mfma_f32_16x16x32_bf16 v[36:39], v[170:173], v[72:75], 0
    v_mfma_f32_16x16x32_bf16 v[64:67], v[170:173], v[76:79], 0
    ds_read_b64_tr_b16 v[170:171], v10 offset:7328
    ds_read_b64_tr_b16 v[172:173], v10 offset:10912
    s_waitcnt lgkmcnt(12)
    v_mfma_f32_16x16x32_bf16 v[40:43], v[174:177], v[72:75], 0
    v_mfma_f32_16x16x32_bf16 v[68:71], v[174:177], v[76:79], 0
    ds_read_b64_tr_b16 v[174:175], v11 offset:7168
    ds_read_b64_tr_b16 v[176:177], v11 offset:10752
    s_waitcnt vmcnt(5) lgkmcnt(12)
    v_mfma_f32_16x16x32_bf16 v[16:19], v[150:153], v[80:83], v[16:19]
    v_mfma_f32_16x16x32_bf16 v[44:47], v[150:153], v[84:87], v[44:47]
    ds_read_b64_tr_b16 v[150:151], v10 offset:14336
    ds_read_b64_tr_b16 v[152:153], v10 offset:17920
    buffer_load_dwordx4 v[104:107], v15, s[40:43], s65 offen offset:0 sc1
    buffer_load_dwordx4 v[108:111], v15, s[40:43], s67 offen offset:0 sc1
    s_waitcnt lgkmcnt(12)
    v_mfma_f32_16x16x32_bf16 v[20:23], v[154:157], v[80:83], v[20:23]
    v_mfma_f32_16x16x32_bf16 v[48:51], v[154:157], v[84:87], v[48:51]
    ds_read_b64_tr_b16 v[154:155], v10 offset:14368
    ds_read_b64_tr_b16 v[156:157], v10 offset:17952
    s_waitcnt lgkmcnt(12)
    v_mfma_f32_16x16x32_bf16 v[24:27], v[158:161], v[80:83], v[24:27]
    v_mfma_f32_16x16x32_bf16 v[52:55], v[158:161], v[84:87], v[52:55]
    ds_read_b64_tr_b16 v[158:159], v10 offset:14400
    ds_read_b64_tr_b16 v[160:161], v10 offset:17984
    s_waitcnt lgkmcnt(12)
    v_mfma_f32_16x16x32_bf16 v[28:31], v[162:165], v[80:83], v[28:31]
    v_mfma_f32_16x16x32_bf16 v[56:59], v[162:165], v[84:87], v[56:59]
    ds_read_b64_tr_b16 v[162:163], v10 offset:14432
    ds_read_b64_tr_b16 v[164:165], v10 offset:18016
    s_add_u32 s48, s69, 8192
    s_add_u32 s49, s70, 1024
    s_mov_b32 m0, s49
    s_nop 0
    buffer_load_dwordx4 v245, s[20:23], s48 offen lds
    s_waitcnt lgkmcnt(12)
    v_mfma_f32_16x16x32_bf16 v[32:35], v[166:169], v[80:83], v[32:35]
    v_mfma_f32_16x16x32_bf16 v[60:63], v[166:169], v[84:87], v[60:63]
    ds_read_b64_tr_b16 v[166:167], v10 offset:14464
    ds_read_b64_tr_b16 v[168:169], v10 offset:18048
    s_waitcnt lgkmcnt(12)
    v_mfma_f32_16x16x32_bf16 v[36:39], v[170:173], v[80:83], v[36:39]
    v_mfma_f32_16x16x32_bf16 v[64:67], v[170:173], v[84:87], v[64:67]
    ds_read_b64_tr_b16 v[170:171], v10 offset:14496
    ds_read_b64_tr_b16 v[172:173], v10 offset:18080
    s_waitcnt lgkmcnt(12)
    v_mfma_f32_16x16x32_bf16 v[40:43], v[174:177], v[80:83], v[40:43]
    v_mfma_f32_16x16x32_bf16 v[68:71], v[174:177], v[84:87], v[68:71]
    ds_read_b64_tr_b16 v[174:175], v11 offset:14336
    ds_read_b64_tr_b16 v[176:177], v11 offset:17920
    s_waitcnt vmcnt(6) lgkmcnt(12)
    v_mfma_f32_16x16x32_bf16 v[16:19], v[150:153], v[88:91], v[16:19]
    v_mfma_f32_16x16x32_bf16 v[44:47], v[150:153], v[92:95], v[44:47]
    ds_read_b64_tr_b16 v[150:151], v10 offset:21504
    ds_read_b64_tr_b16 v[152:153], v10 offset:25088
    buffer_load_dwordx4 v[112:115], v15, s[40:43], s65 offen offset:1024 sc1
    buffer_load_dwordx4 v[116:119], v15, s[40:43], s67 offen offset:1024 sc1
    s_waitcnt lgkmcnt(12)
    v_mfma_f32_16x16x32_bf16 v[20:23], v[154:157], v[88:91], v[20:23]
    v_mfma_f32_16x16x32_bf16 v[48:51], v[154:157], v[92:95], v[48:51]
    ds_read_b64_tr_b16 v[154:155], v10 offset:21536
    ds_read_b64_tr_b16 v[156:157], v10 offset:25120
    s_waitcnt lgkmcnt(12)
    v_mfma_f32_16x16x32_bf16 v[24:27], v[158:161], v[88:91], v[24:27]
    v_mfma_f32_16x16x32_bf16 v[52:55], v[158:161], v[92:95], v[52:55]
    ds_read_b64_tr_b16 v[158:159], v10 offset:21568
    ds_read_b64_tr_b16 v[160:161], v10 offset:25152
    s_waitcnt lgkmcnt(12)
    v_mfma_f32_16x16x32_bf16 v[28:31], v[162:165], v[88:91], v[28:31]
    v_mfma_f32_16x16x32_bf16 v[56:59], v[162:165], v[92:95], v[56:59]
    ds_read_b64_tr_b16 v[162:163], v10 offset:21600
    ds_read_b64_tr_b16 v[164:165], v10 offset:25184
    s_add_u32 s48, s69, 32768
    s_add_u32 s49, s70, 4096
    s_mov_b32 m0, s49
    s_nop 0
    buffer_load_dwordx4 v245, s[20:23], s48 offen lds
    s_waitcnt lgkmcnt(12)
    v_mfma_f32_16x16x32_bf16 v[32:35], v[166:169], v[88:91], v[32:35]
    v_mfma_f32_16x16x32_bf16 v[60:63], v[166:169], v[92:95], v[60:63]
    ds_read_b64_tr_b16 v[166:167], v10 offset:21632
    ds_read_b64_tr_b16 v[168:169], v10 offset:25216
    s_waitcnt lgkmcnt(12)
    v_mfma_f32_16x16x32_bf16 v[36:39], v[170:173], v[88:91], v[36:39]
    v_mfma_f32_16x16x32_bf16 v[64:67], v[170:173], v[92:95], v[64:67]
    ds_read_b64_tr_b16 v[170:171], v10 offset:21664
    ds_read_b64_tr_b16 v[172:173], v10 offset:25248
    s_waitcnt lgkmcnt(12)
    v_mfma_f32_16x16x32_bf16 v[40:43], v[174:177], v[88:91], v[40:43]
    v_mfma_f32_16x16x32_bf16 v[68:71], v[174:177], v[92:95], v[68:71]
    ds_read_b64_tr_b16 v[174:175], v11 offset:21504
    ds_read_b64_tr_b16 v[176:177], v11 offset:25088
    s_waitcnt vmcnt(7) lgkmcnt(12)
    v_mfma_f32_16x16x32_bf16 v[16:19], v[150:153], v[96:99], v[16:19]
    v_mfma_f32_16x16x32_bf16 v[44:47], v[150:153], v[100:103], v[44:47]
    ds_read_b64_tr_b16 v[150:151], v10 offset:28672
    ds_read_b64_tr_b16 v[152:153], v10 offset:32256
    buffer_load_dwordx4 v[120:123], v15, s[40:43], s65 offen offset:2048 sc1
    buffer_load_dwordx4 v[124:127], v15, s[40:43], s67 offen offset:2048 sc1
    s_waitcnt lgkmcnt(12)
    v_mfma_f32_16x16x32_bf16 v[20:23], v[154:157], v[96:99], v[20:23]
    v_mfma_f32_16x16x32_bf16 v[48:51], v[154:157], v[100:103], v[48:51]
    ds_read_b64_tr_b16 v[154:155], v10 offset:28704
    ds_read_b64_tr_b16 v[156:157], v10 offset:32288
    s_waitcnt lgkmcnt(12)
    v_mfma_f32_16x16x32_bf16 v[24:27], v[158:161], v[96:99], v[24:27]
    v_mfma_f32_16x16x32_bf16 v[52:55], v[158:161], v[100:103], v[52:55]
    ds_read_b64_tr_b16 v[158:159], v10 offset:28736
    ds_read_b64_tr_b16 v[160:161], v10 offset:32320
    s_waitcnt lgkmcnt(12)
    v_mfma_f32_16x16x32_bf16 v[28:31], v[162:165], v[96:99], v[28:31]
    v_mfma_f32_16x16x32_bf16 v[56:59], v[162:165], v[100:103], v[56:59]
    ds_read_b64_tr_b16 v[162:163], v10 offset:28768
    ds_read_b64_tr_b16 v[164:165], v10 offset:32352
    s_add_u32 s48, s69, 40960
    s_add_u32 s49, s70, 5120
    s_mov_b32 m0, s49
    s_nop 0
    buffer_load_dwordx4 v245, s[20:23], s48 offen lds
    s_waitcnt lgkmcnt(12)
    v_mfma_f32_16x16x32_bf16 v[32:35], v[166:169], v[96:99], v[32:35]
    v_mfma_f32_16x16x32_bf16 v[60:63], v[166:169], v[100:103], v[60:63]
    ds_read_b64_tr_b16 v[166:167], v10 offset:28800
    ds_read_b64_tr_b16 v[168:169], v10 offset:32384
    s_waitcnt lgkmcnt(12)
    v_mfma_f32_16x16x32_bf16 v[36:39], v[170:173], v[96:99], v[36:39]
    v_mfma_f32_16x16x32_bf16 v[64:67], v[170:173], v[100:103], v[64:67]
    ds_read_b64_tr_b16 v[170:171], v10 offset:28832
    ds_read_b64_tr_b16 v[172:173], v10 offset:32416
    s_waitcnt lgkmcnt(12)
    v_mfma_f32_16x16x32_bf16 v[40:43], v[174:177], v[96:99], v[40:43]
    v_mfma_f32_16x16x32_bf16 v[68:71], v[174:177], v[100:103], v[68:71]
    ds_read_b64_tr_b16 v[174:175], v11 offset:28672
    ds_read_b64_tr_b16 v[176:177], v11 offset:32256
    s_waitcnt vmcnt(7) lgkmcnt(12)
    v_mfma_f32_16x16x32_bf16 v[16:19], v[150:153], v[104:107], v[16:19]
    v_mfma_f32_16x16x32_bf16 v[44:47], v[150:153], v[108:111], v[44:47]
    ds_read_b64_tr_b16 v[150:151], v10 offset:35840
    ds_read_b64_tr_b16 v[152:153], v10 offset:39424
    buffer_load_dwordx4 v[128:131], v15, s[40:43], s65 offen offset:3072 sc1
    buffer_load_dwordx4 v[132:135], v15, s[40:43], s67 offen offset:3072 sc1
    s_waitcnt lgkmcnt(12)
    v_mfma_f32_16x16x32_bf16 v[20:23], v[154:157], v[104:107], v[20:23]
    v_mfma_f32_16x16x32_bf16 v[48:51], v[154:157], v[108:111], v[48:51]
    ds_read_b64_tr_b16 v[154:155], v10 offset:35872
    ds_read_b64_tr_b16 v[156:157], v10 offset:39456
    s_waitcnt lgkmcnt(12)
    v_mfma_f32_16x16x32_bf16 v[24:27], v[158:161], v[104:107], v[24:27]
    v_mfma_f32_16x16x32_bf16 v[52:55], v[158:161], v[108:111], v[52:55]
    ds_read_b64_tr_b16 v[158:159], v10 offset:35904
    ds_read_b64_tr_b16 v[160:161], v10 offset:39488
    s_waitcnt lgkmcnt(12)
    v_mfma_f32_16x16x32_bf16 v[28:31], v[162:165], v[104:107], v[28:31]
    v_mfma_f32_16x16x32_bf16 v[56:59], v[162:165], v[108:111], v[56:59]
    ds_read_b64_tr_b16 v[162:163], v10 offset:35936
    ds_read_b64_tr_b16 v[164:165], v10 offset:39520
    s_add_u32 s48, s69, 65536
    s_add_u32 s49, s70, 8192
    s_mov_b32 m0, s49
    s_nop 0
    buffer_load_dwordx4 v245, s[20:23], s48 offen lds
    s_waitcnt lgkmcnt(12)
    v_mfma_f32_16x16x32_bf16 v[32:35], v[166:169], v[104:107], v[32:35]
    v_mfma_f32_16x16x32_bf16 v[60:63], v[166:169], v[108:111], v[60:63]
    ds_read_b64_tr_b16 v[166:167], v10 offset:35968
    ds_read_b64_tr_b16 v[168:169], v10 offset:39552
    s_waitcnt lgkmcnt(12)
    v_mfma_f32_16x16x32_bf16 v[36:39], v[170:173], v[104:107], v[36:39]
    v_mfma_f32_16x16x32_bf16 v[64:67], v[170:173], v[108:111], v[64:67]
    ds_read_b64_tr_b16 v[170:171], v10 offset:36000
    ds_read_b64_tr_b16 v[172:173], v10 offset:39584
    s_waitcnt lgkmcnt(12)
    v_mfma_f32_16x16x32_bf16 v[40:43], v[174:177], v[104:107], v[40:43]
    v_mfma_f32_16x16x32_bf16 v[68:71], v[174:177], v[108:111], v[68:71]
    ds_read_b64_tr_b16 v[174:175], v11 offset:35840
    ds_read_b64_tr_b16 v[176:177], v11 offset:39424
    s_waitcnt vmcnt(7) lgkmcnt(12)
    v_mfma_f32_16x16x32_bf16 v[16:19], v[150:153], v[112:115], v[16:19]
    v_mfma_f32_16x16x32_bf16 v[44:47], v[150:153], v[116:119], v[44:47]
    ds_read_b64_tr_b16 v[150:151], v10 offset:43008
    ds_read_b64_tr_b16 v[152:153], v10 offset:46592
    s_waitcnt lgkmcnt(12)
    v_mfma_f32_16x16x32_bf16 v[20:23], v[154:157], v[112:115], v[20:23]
    v_mfma_f32_16x16x32_bf16 v[48:51], v[154:157], v[116:119], v[48:51]
    ds_read_b64_tr_b16 v[154:155], v10 offset:43040
    ds_read_b64_tr_b16 v[156:157], v10 offset:46624
    s_waitcnt lgkmcnt(12)
    v_mfma_f32_16x16x32_bf16 v[24:27], v[158:161], v[112:115], v[24:27]
    v_mfma_f32_16x16x32_bf16 v[52:55], v[158:161], v[116:119], v[52:55]
    ds_read_b64_tr_b16 v[158:159], v10 offset:43072
    ds_read_b64_tr_b16 v[160:161], v10 offset:46656
    s_waitcnt lgkmcnt(12)
    v_mfma_f32_16x16x32_bf16 v[28:31], v[162:165], v[112:115], v[28:31]
    v_mfma_f32_16x16x32_bf16 v[56:59], v[162:165], v[116:119], v[56:59]
    ds_read_b64_tr_b16 v[162:163], v10 offset:43104
    ds_read_b64_tr_b16 v[164:165], v10 offset:46688
    s_add_u32 s48, s69, 73728
    s_add_u32 s49, s70, 9216
    s_mov_b32 m0, s49
    s_nop 0
    buffer_load_dwordx4 v245, s[20:23], s48 offen lds
    s_waitcnt lgkmcnt(12)
    v_mfma_f32_16x16x32_bf16 v[32:35], v[166:169], v[112:115], v[32:35]
    v_mfma_f32_16x16x32_bf16 v[60:63], v[166:169], v[116:119], v[60:63]
    ds_read_b64_tr_b16 v[166:167], v10 offset:43136
    ds_read_b64_tr_b16 v[168:169], v10 offset:46720
    s_waitcnt lgkmcnt(12)
    v_mfma_f32_16x16x32_bf16 v[36:39], v[170:173], v[112:115], v[36:39]
    v_mfma_f32_16x16x32_bf16 v[64:67], v[170:173], v[116:119], v[64:67]
    ds_read_b64_tr_b16 v[170:171], v10 offset:43168
    ds_read_b64_tr_b16 v[172:173], v10 offset:46752
    s_waitcnt lgkmcnt(12)
    v_mfma_f32_16x16x32_bf16 v[40:43], v[174:177], v[112:115], v[40:43]
    v_mfma_f32_16x16x32_bf16 v[68:71], v[174:177], v[116:119], v[68:71]
    ds_read_b64_tr_b16 v[174:175], v11 offset:43008
    ds_read_b64_tr_b16 v[176:177], v11 offset:46592
    s_waitcnt vmcnt(5) lgkmcnt(12)
    v_mfma_f32_16x16x32_bf16 v[16:19], v[150:153], v[120:123], v[16:19]
    v_mfma_f32_16x16x32_bf16 v[44:47], v[150:153], v[124:127], v[44:47]
    ds_read_b64_tr_b16 v[150:151], v10 offset:50176
    ds_read_b64_tr_b16 v[152:153], v10 offset:53760
    s_waitcnt lgkmcnt(12)
    v_mfma_f32_16x16x32_bf16 v[20:23], v[154:157], v[120:123], v[20:23]
    v_mfma_f32_16x16x32_bf16 v[48:51], v[154:157], v[124:127], v[48:51]
    ds_read_b64_tr_b16 v[154:155], v10 offset:50208
    ds_read_b64_tr_b16 v[156:157], v10 offset:53792
    s_waitcnt lgkmcnt(12)
    v_mfma_f32_16x16x32_bf16 v[24:27], v[158:161], v[120:123], v[24:27]
    v_mfma_f32_16x16x32_bf16 v[52:55], v[158:161], v[124:127], v[52:55]
    ds_read_b64_tr_b16 v[158:159], v10 offset:50240
    ds_read_b64_tr_b16 v[160:161], v10 offset:53824
    s_waitcnt lgkmcnt(12)
    v_mfma_f32_16x16x32_bf16 v[28:31], v[162:165], v[120:123], v[28:31]
    v_mfma_f32_16x16x32_bf16 v[56:59], v[162:165], v[124:127], v[56:59]
    ds_read_b64_tr_b16 v[162:163], v10 offset:50272
    ds_read_b64_tr_b16 v[164:165], v10 offset:53856
    s_waitcnt lgkmcnt(12)
    v_mfma_f32_16x16x32_bf16 v[32:35], v[166:169], v[120:123], v[32:35]
    v_mfma_f32_16x16x32_bf16 v[60:63], v[166:169], v[124:127], v[60:63]
    ds_read_b64_tr_b16 v[166:167], v10 offset:50304
    ds_read_b64_tr_b16 v[168:169], v10 offset:53888
    s_waitcnt lgkmcnt(12)
    v_mfma_f32_16x16x32_bf16 v[36:39], v[170:173], v[120:123], v[36:39]
    v_mfma_f32_16x16x32_bf16 v[64:67], v[170:173], v[124:127], v[64:67]
    ds_read_b64_tr_b16 v[170:171], v10 offset:50336
    ds_read_b64_tr_b16 v[172:173], v10 offset:53920
    s_waitcnt lgkmcnt(12)
    v_mfma_f32_16x16x32_bf16 v[40:43], v[174:177], v[120:123], v[40:43]
    v_mfma_f32_16x16x32_bf16 v[68:71], v[174:177], v[124:127], v[68:71]
    ds_read_b64_tr_b16 v[174:175], v11 offset:50176
    ds_read_b64_tr_b16 v[176:177], v11 offset:53760
    s_waitcnt vmcnt(2) lgkmcnt(12)
    v_mfma_f32_16x16x32_bf16 v[16:19], v[150:153], v[128:131], v[16:19]
    v_mfma_f32_16x16x32_bf16 v[44:47], v[150:153], v[132:135], v[44:47]
    s_waitcnt lgkmcnt(10)
    v_mfma_f32_16x16x32_bf16 v[20:23], v[154:157], v[128:131], v[20:23]
    v_mfma_f32_16x16x32_bf16 v[48:51], v[154:157], v[132:135], v[48:51]
    s_waitcnt lgkmcnt(8)
    v_mfma_f32_16x16x32_bf16 v[24:27], v[158:161], v[128:131], v[24:27]
    v_mfma_f32_16x16x32_bf16 v[52:55], v[158:161], v[132:135], v[52:55]
    s_waitcnt lgkmcnt(6)
    v_mfma_f32_16x16x32_bf16 v[28:31], v[162:165], v[128:131], v[28:31]
    v_mfma_f32_16x16x32_bf16 v[56:59], v[162:165], v[132:135], v[56:59]
    s_waitcnt lgkmcnt(4)
    v_mfma_f32_16x16x32_bf16 v[32:35], v[166:169], v[128:131], v[32:35]
    v_mfma_f32_16x16x32_bf16 v[60:63], v[166:169], v[132:135], v[60:63]
    s_waitcnt lgkmcnt(2)
    v_mfma_f32_16x16x32_bf16 v[36:39], v[170:173], v[128:131], v[36:39]
    v_mfma_f32_16x16x32_bf16 v[64:67], v[170:173], v[132:135], v[64:67]
    s_waitcnt lgkmcnt(0)
    v_mfma_f32_16x16x32_bf16 v[40:43], v[174:177], v[128:131], v[40:43]
    v_mfma_f32_16x16x32_bf16 v[68:71], v[174:177], v[132:135], v[68:71]
    s_mul_i32 s48, s46, 7168
    s_xor_b32 s49, s46, 4
    s_mul_i32 s49, s49, 7168
    v_add_u32 v12, s48, v15
    v_add_u32 v13, s49, v15
    s_barrier
    s_nop 1
    ds_write_b128 v12, v[44:47] offset:0
    ds_write_b128 v12, v[48:51] offset:1024
    ds_write_b128 v12, v[52:55] offset:2048
    ds_write_b128 v12, v[56:59] offset:3072
    ds_write_b128 v12, v[60:63] offset:4096
    ds_write_b128 v12, v[64:67] offset:5120
    ds_write_b128 v12, v[68:71] offset:6144
    s_waitcnt lgkmcnt(0)
    s_barrier
    ds_read_b128 v[72:75], v13 offset:0
    ds_read_b128 v[76:79], v13 offset:1024
    ds_read_b128 v[80:83], v13 offset:2048
    ds_read_b128 v[84:87], v13 offset:3072
    ds_read_b128 v[88:91], v13 offset:4096
    ds_read_b128 v[92:95], v13 offset:5120
    ds_read_b128 v[96:99], v13 offset:6144
    v_add_f32 v2, v2, v4
    v_add_f32 v3, v3, v5
    v_add_f32 v6, v6, v8
    v_add_f32 v7, v7, v9
    v_add_f32 v2, v2, v6
    v_add_f32 v3, v3, v7
    v_mov_b32 v4, v2
    s_nop 1
    v_permlane16_swap_b32 v2, v4
    v_add_f32 v2, v2, v4
    v_mov_b32 v4, v2
    s_nop 1
    v_permlane32_swap_b32 v2, v4
    v_add_f32 v2, v2, v4
    v_mov_b32 v5, v3
    s_nop 1
    v_permlane16_swap_b32 v3, v5
    v_add_f32 v3, v3, v5
    v_mov_b32 v5, v3
    s_nop 1
    v_permlane32_swap_b32 v3, v5
    v_add_f32 v3, v3, v5
    v_mul_f32 v2, 0x3b000000, v2
    v_mul_f32 v3, 0x3b000000, v3
    v_fma_f32 v3, -v2, v2, v3
    v_max_f32 v3, 0, v3
    v_add_f32 v3, 0x3727c5ac, v3
    v_rsq_f32 v3, v3
    s_mul_i32 s48, s95, 56
    s_waitcnt lgkmcnt(0)
    v_mul_f32 v2, v2, v3
    s_barrier
    s_lshr_b32 s49, s45, 1
    s_mul_i32 s49, s49, 7
    s_add_u32 s48, s48, s49
    s_lshl_b32 s48, s48, 10
    s_add_u32 s48, s48, 8716288
    s_lshl_b32 s49, s94, 12
    s_add_u32 s55, s48, s49
    s_lshl_b32 s49, s94, 9
    v_lshlrev_b32 v14, 3, v1
    s_add_u32 s98, s48, s49
    s_add_u32 s48, s69, 98304
    s_add_u32 s49, s71, 0
    s_mov_b32 m0, s49
    s_nop 0
    buffer_load_dwordx4 v245, s[20:23], s48 offen lds
    s_add_u32 s48, s69, 106496
    s_add_u32 s49, s71, 1024
    s_mov_b32 m0, s49
    s_nop 0
    buffer_load_dwordx4 v245, s[20:23], s48 offen lds
    s_mov_b32 s48, s98
    v_lshlrev_b32 v4, 16, v206
    v_add_f32 v16, v16, v72
    v_fma_f32 v4, -v2, v178, v4
    v_fma_f32 v4, v16, v3, v4
    v_max_f32 v4, 0, v4
    v_mul_f32 v16, v4, v4
    v_and_b32 v4, 0xffff0000, v206
    v_add_f32 v17, v17, v73
    v_fma_f32 v4, -v2, v179, v4
    v_fma_f32 v4, v17, v3, v4
    v_max_f32 v4, 0, v4
    v_mul_f32 v17, v4, v4
    v_lshlrev_b32 v4, 16, v207
    v_add_f32 v18, v18, v74
    v_fma_f32 v4, -v2, v180, v4
    v_fma_f32 v4, v18, v3, v4
    v_max_f32 v4, 0, v4
    v_mul_f32 v18, v4, v4
    v_and_b32 v4, 0xffff0000, v207
    v_add_f32 v19, v19, v75
    v_fma_f32 v4, -v2, v181, v4
    v_fma_f32 v4, v19, v3, v4
    v_max_f32 v4, 0, v4
    v_mul_f32 v19, v4, v4
    v_cvt_pk_bf16_f32 v150, v16, v17
    v_cvt_pk_bf16_f32 v151, v18, v19
    v_lshlrev_b32 v4, 16, v208
    v_add_f32 v20, v20, v76
    v_fma_f32 v4, -v2, v182, v4
    v_fma_f32 v4, v20, v3, v4
    v_max_f32 v4, 0, v4
    v_mul_f32 v20, v4, v4
    v_and_b32 v4, 0xffff0000, v208
    v_add_f32 v21, v21, v77
    v_fma_f32 v4, -v2, v183, v4
    v_fma_f32 v4, v21, v3, v4
    v_max_f32 v4, 0, v4
    v_mul_f32 v21, v4, v4
    v_lshlrev_b32 v4, 16, v209
    v_add_f32 v22, v22, v78
    v_fma_f32 v4, -v2, v184, v4
    v_fma_f32 v4, v22, v3, v4
    v_max_f32 v4, 0, v4
    v_mul_f32 v22, v4, v4
    v_and_b32 v4, 0xffff0000, v209
    v_add_f32 v23, v23, v79
    v_fma_f32 v4, -v2, v185, v4
    v_fma_f32 v4, v23, v3, v4
    v_max_f32 v4, 0, v4
    v_mul_f32 v23, v4, v4
    v_cvt_pk_bf16_f32 v152, v20, v21
    v_cvt_pk_bf16_f32 v153, v22, v23
    buffer_store_dwordx4 v[150:153], v15, s[40:43], s55 offen offset:0 sc1
    v_lshlrev_b32 v4, 16, v210
    v_add_f32 v24, v24, v80
    v_fma_f32 v4, -v2, v186, v4
    v_fma_f32 v4, v24, v3, v4
    v_max_f32 v4, 0, v4
    v_mul_f32 v24, v4, v4
    v_and_b32 v4, 0xffff0000, v210
    v_add_f32 v25, v25, v81
    v_fma_f32 v4, -v2, v187, v4
    v_fma_f32 v4, v25, v3, v4
    v_max_f32 v4, 0, v4
    v_mul_f32 v25, v4, v4
    v_lshlrev_b32 v4, 16, v211
    v_add_f32 v26, v26, v82
    v_fma_f32 v4, -v2, v188, v4
    v_fma_f32 v4, v26, v3, v4
    v_max_f32 v4, 0, v4
    v_mul_f32 v26, v4, v4
    v_and_b32 v4, 0xffff0000, v211
    v_add_f32 v27, v27, v83
    v_fma_f32 v4, -v2, v189, v4
    v_fma_f32 v4, v27, v3, v4
    v_max_f32 v4, 0, v4
    v_mul_f32 v27, v4, v4
    v_cvt_pk_bf16_f32 v154, v24, v25
    v_cvt_pk_bf16_f32 v155, v26, v27
    v_lshlrev_b32 v4, 16, v212
    v_add_f32 v28, v28, v84
    v_fma_f32 v4, -v2, v190, v4
    v_fma_f32 v4, v28, v3, v4
    v_max_f32 v4, 0, v4
    v_mul_f32 v28, v4, v4
    v_and_b32 v4, 0xffff0000, v212
    v_add_f32 v29, v29, v85
    v_fma_f32 v4, -v2, v191, v4
    v_fma_f32 v4, v29, v3, v4
    v_max_f32 v4, 0, v4
    v_mul_f32 v29, v4, v4
    v_lshlrev_b32 v4, 16, v213
    v_add_f32 v30, v30, v86
    v_fma_f32 v4, -v2, v192, v4
    v_fma_f32 v4, v30, v3, v4
    v_max_f32 v4, 0, v4
    v_mul_f32 v30, v4, v4
    v_and_b32 v4, 0xffff0000, v213
    v_add_f32 v31, v31, v87
    v_fma_f32 v4, -v2, v193, v4
    v_fma_f32 v4, v31, v3, v4
    v_max_f32 v4, 0, v4
    v_mul_f32 v31, v4, v4
    v_cvt_pk_bf16_f32 v156, v28, v29
    v_cvt_pk_bf16_f32 v157, v30, v31
    buffer_store_dwordx4 v[154:157], v15, s[40:43], s55 offen offset:1024 sc1
    v_lshlrev_b32 v4, 16, v214
    v_add_f32 v32, v32, v88
    v_fma_f32 v4, -v2, v194, v4
    v_fma_f32 v4, v32, v3, v4
    v_max_f32 v4, 0, v4
    v_mul_f32 v32, v4, v4
    v_and_b32 v4, 0xffff0000, v214
    v_add_f32 v33, v33, v89
    v_fma_f32 v4, -v2, v195, v4
    v_fma_f32 v4, v33, v3, v4
    v_max_f32 v4, 0, v4
    v_mul_f32 v33, v4, v4
    v_lshlrev_b32 v4, 16, v215
    v_add_f32 v34, v34, v90
    v_fma_f32 v4, -v2, v196, v4
    v_fma_f32 v4, v34, v3, v4
    v_max_f32 v4, 0, v4
    v_mul_f32 v34, v4, v4
    v_and_b32 v4, 0xffff0000, v215
    v_add_f32 v35, v35, v91
    v_fma_f32 v4, -v2, v197, v4
    v_fma_f32 v4, v35, v3, v4
    v_max_f32 v4, 0, v4
    v_mul_f32 v35, v4, v4
    v_cvt_pk_bf16_f32 v158, v32, v33
    v_cvt_pk_bf16_f32 v159, v34, v35
    v_lshlrev_b32 v4, 16, v216
    v_add_f32 v36, v36, v92
    v_fma_f32 v4, -v2, v198, v4
    v_fma_f32 v4, v36, v3, v4
    v_max_f32 v4, 0, v4
    v_mul_f32 v36, v4, v4
    v_and_b32 v4, 0xffff0000, v216
    v_add_f32 v37, v37, v93
    v_fma_f32 v4, -v2, v199, v4
    v_fma_f32 v4, v37, v3, v4
    v_max_f32 v4, 0, v4
    v_mul_f32 v37, v4, v4
    v_lshlrev_b32 v4, 16, v217
    v_add_f32 v38, v38, v94
    v_fma_f32 v4, -v2, v200, v4
    v_fma_f32 v4, v38, v3, v4
    v_max_f32 v4, 0, v4
    v_mul_f32 v38, v4, v4
    v_and_b32 v4, 0xffff0000, v217
    v_add_f32 v39, v39, v95
    v_fma_f32 v4, -v2, v201, v4
    v_fma_f32 v4, v39, v3, v4
    v_max_f32 v4, 0, v4
    v_mul_f32 v39, v4, v4
    v_cvt_pk_bf16_f32 v160, v36, v37
    v_cvt_pk_bf16_f32 v161, v38, v39
    buffer_store_dwordx4 v[158:161], v15, s[40:43], s55 offen offset:2048 sc1
    v_lshlrev_b32 v4, 16, v218
    v_add_f32 v40, v40, v96
    v_fma_f32 v4, -v2, v202, v4
    v_fma_f32 v4, v40, v3, v4
    v_max_f32 v4, 0, v4
    v_mul_f32 v40, v4, v4
    v_and_b32 v4, 0xffff0000, v218
    v_add_f32 v41, v41, v97
    v_fma_f32 v4, -v2, v203, v4
    v_fma_f32 v4, v41, v3, v4
    v_max_f32 v4, 0, v4
    v_mul_f32 v41, v4, v4
    v_lshlrev_b32 v4, 16, v219
    v_add_f32 v42, v42, v98
    v_fma_f32 v4, -v2, v204, v4
    v_fma_f32 v4, v42, v3, v4
    v_max_f32 v4, 0, v4
    v_mul_f32 v42, v4, v4
    v_and_b32 v4, 0xffff0000, v219
    v_add_f32 v43, v43, v99
    v_fma_f32 v4, -v2, v205, v4
    v_fma_f32 v4, v43, v3, v4
    v_max_f32 v4, 0, v4
    v_mul_f32 v43, v4, v4
    v_cvt_pk_bf16_f32 v162, v40, v41
    v_cvt_pk_bf16_f32 v163, v42, v43
    buffer_store_dwordx2 v[162:163], v14, s[40:43], s48 offen offset:3072 sc1
    s_add_u32 s48, s69, 131072
    s_add_u32 s49, s71, 4096
    s_mov_b32 m0, s49
    s_nop 0
    buffer_load_dwordx4 v245, s[20:23], s48 offen lds
    s_add_u32 s48, s69, 139264
    s_add_u32 s49, s71, 5120
    s_mov_b32 m0, s49
    s_nop 0
    buffer_load_dwordx4 v245, s[20:23], s48 offen lds
    s_add_u32 s48, s69, 163840
    s_add_u32 s49, s71, 8192
    s_mov_b32 m0, s49
    s_nop 0
    buffer_load_dwordx4 v245, s[20:23], s48 offen lds
    s_add_u32 s48, s69, 172032
    s_add_u32 s49, s71, 9216
    s_mov_b32 m0, s49
    s_nop 0
    buffer_load_dwordx4 v245, s[20:23], s48 offen lds
    s_add_u32 s48, s69, 196608
    s_add_u32 s49, s71, 12288
    s_mov_b32 m0, s49
    s_nop 0
    buffer_load_dwordx4 v245, s[20:23], s48 offen lds
    s_add_u32 s48, s69, 204800
    s_add_u32 s49, s71, 13312
    s_mov_b32 m0, s49
    s_nop 0
    buffer_load_dwordx4 v245, s[20:23], s48 offen lds
    s_waitcnt vmcnt(6)
    s_barrier
    s_cmp_lg_u32 s46, 0
    s_cbranch_scc1 Lsf_51
    s_lshl_b32 s48, s44, 10
    s_lshl_b32 s49, s45, 6
    s_add_u32 s48, s48, s49
    s_add_u32 s48, s48, 49152
    v_mov_b32 v250, s47
    v_lshl_add_u32 v251, v1, 2, s48
    s_mov_b64 exec, 0xffff
    buffer_store_dword v250, v251, s[40:43], 0 offen sc1
    s_mov_b64 exec, -1
    Lsf_51:
    s_add_u32 s48, s69, 229376
    s_add_u32 s49, s71, 16384
    s_mov_b32 m0, s49
    s_nop 0
    buffer_load_dwordx4 v245, s[20:23], s48 offen lds
    s_add_u32 s48, s69, 237568
    s_add_u32 s49, s71, 17408
    s_mov_b32 m0, s49
    s_nop 0
    buffer_load_dwordx4 v245, s[20:23], s48 offen lds
    s_add_u32 s48, s69, 262144
    s_add_u32 s49, s71, 20480
    s_mov_b32 m0, s49
    s_nop 0
    buffer_load_dwordx4 v245, s[20:23], s48 offen lds
    s_add_u32 s48, s69, 270336
    s_add_u32 s49, s71, 21504
    s_mov_b32 m0, s49
    s_nop 0
    buffer_load_dwordx4 v245, s[20:23], s48 offen lds
    s_add_u32 s48, s69, 294912
    s_add_u32 s49, s71, 24576
    s_mov_b32 m0, s49
    s_nop 0
    buffer_load_dwordx4 v245, s[20:23], s48 offen lds
    s_add_u32 s48, s69, 303104
    s_add_u32 s49, s71, 25600
    s_mov_b32 m0, s49
    s_nop 0
    buffer_load_dwordx4 v245, s[20:23], s48 offen lds
    v_lshrrev_b32 v10, 2, v1
    v_lshlrev_b32 v11, 7, v10
    v_and_b32 v12, 3, v1
    v_lshl_add_u32 v11, v12, 3, v11
    v_bfe_u32 v10, v10, 1, 2
    s_mul_i32 s48, s89, 12288
    s_add_u32 s48, s48, 114688
    s_mul_i32 s49, s89, 28672
    v_xor_b32 v12, 0, v10
    v_lshl_add_u32 v12, v12, 5, v11
    v_add_u32 v2, s48, v12
    v_add_u32 v6, s49, v12
    v_xor_b32 v12, 1, v10
    v_lshl_add_u32 v12, v12, 5, v11
    v_add_u32 v3, s48, v12
    v_add_u32 v7, s49, v12
    v_xor_b32 v12, 2, v10
    v_lshl_add_u32 v12, v12, 5, v11
    v_add_u32 v4, s48, v12
    v_add_u32 v8, s49, v12
    v_xor_b32 v12, 3, v10
    v_lshl_add_u32 v12, v12, 5, v11
    v_add_u32 v5, s48, v12
    v_add_u32 v9, s49, v12
    v_lshlrev_b32 v10, 3, v1
    ds_read_b64_tr_b16 v[160:161], v2 offset:0
    ds_read_b64_tr_b16 v[162:163], v2 offset:2048
    ds_read_b64_tr_b16 v[164:165], v3 offset:0
    ds_read_b64_tr_b16 v[166:167], v3 offset:2048
    ds_read_b64_tr_b16 v[168:169], v4 offset:0
    ds_read_b64_tr_b16 v[170:171], v4 offset:2048
    ds_read_b64_tr_b16 v[172:173], v5 offset:0
    ds_read_b64_tr_b16 v[174:175], v5 offset:2048
    ds_read_b64_tr_b16 v[176:177], v2 offset:4096
    ds_read_b64_tr_b16 v[178:179], v2 offset:6144
    ds_read_b64_tr_b16 v[180:181], v3 offset:4096
    ds_read_b64_tr_b16 v[182:183], v3 offset:6144
    ds_read_b64_tr_b16 v[184:185], v4 offset:4096
    ds_read_b64_tr_b16 v[186:187], v4 offset:6144
    ds_read_b64_tr_b16 v[188:189], v5 offset:4096
    ds_read_b64_tr_b16 v[190:191], v5 offset:6144
    ds_read_b64_tr_b16 v[192:193], v2 offset:8192
    ds_read_b64_tr_b16 v[194:195], v2 offset:10240
    ds_read_b64_tr_b16 v[196:197], v3 offset:8192
    ds_read_b64_tr_b16 v[198:199], v3 offset:10240
    ds_read_b64_tr_b16 v[200:201], v4 offset:8192
    ds_read_b64_tr_b16 v[202:203], v4 offset:10240
    ds_read_b64_tr_b16 v[204:205], v5 offset:8192
    ds_read_b64_tr_b16 v[206:207], v5 offset:10240
    ds_read_b64_tr_b16 v[208:209], v6 offset:0
    ds_read_b64_tr_b16 v[210:211], v6 offset:2048
    ds_read_b64_tr_b16 v[212:213], v7 offset:0
    ds_read_b64_tr_b16 v[214:215], v7 offset:2048
    ds_read_b64_tr_b16 v[216:217], v8 offset:0
    ds_read_b64_tr_b16 v[218:219], v8 offset:2048
    ds_read_b64_tr_b16 v[220:221], v9 offset:0
    ds_read_b64_tr_b16 v[222:223], v9 offset:2048
    s_and_b32 s48, s45, 1
    s_lshl_b32 s48, s48, 2
    s_lshl_b32 s49, s88, 1
    s_add_u32 s48, s48, s49
    s_lshl_b32 s49, s44, 3
    s_add_u32 s48, s48, s49
    s_mul_i32 s48, s48, 56
    s_mul_i32 s49, s89, 14
    s_add_u32 s48, s48, s49
    s_lshl_b32 s48, s48, 10
    s_add_u32 s72, s48, 8716288
    s_add_u32 s73, s72, 4096
    s_add_u32 s74, s72, 8192
    s_add_u32 s75, s72, 12288
    s_add_u32 s76, s72, 57344
    s_add_u32 s77, s72, 61440
    s_add_u32 s78, s72, 65536
    s_add_u32 s79, s72, 69632
    s_waitcnt lgkmcnt(0)
    s_barrier
    s_add_u32 s48, s69, 327680
    s_add_u32 s49, s70, 0
    s_mov_b32 m0, s49
    s_nop 0
    buffer_load_dwordx4 v245, s[20:23], s48 offen lds
    s_add_u32 s48, s69, 335872
    s_add_u32 s49, s70, 1024
    s_mov_b32 m0, s49
    s_nop 0
    buffer_load_dwordx4 v245, s[20:23], s48 offen lds
    s_add_u32 s48, s69, 360448
    s_add_u32 s49, s70, 4096
    s_mov_b32 m0, s49
    s_nop 0
    buffer_load_dwordx4 v245, s[20:23], s48 offen lds
    s_add_u32 s48, s69, 368640
    s_add_u32 s49, s70, 5120
    s_mov_b32 m0, s49
    s_nop 0
    buffer_load_dwordx4 v245, s[20:23], s48 offen lds
    s_add_u32 s48, s69, 393216
    s_add_u32 s49, s70, 8192
    s_mov_b32 m0, s49
    s_nop 0
    buffer_load_dwordx4 v245, s[20:23], s48 offen lds
    s_add_u32 s48, s69, 401408
    s_add_u32 s49, s70, 9216
    s_mov_b32 m0, s49
    s_nop 0
    buffer_load_dwordx4 v245, s[20:23], s48 offen lds
    s_add_u32 s48, s69, 425984
    s_add_u32 s49, s71, 0
    s_mov_b32 m0, s49
    s_nop 0
    buffer_load_dwordx4 v245, s[20:23], s48 offen lds
    s_add_u32 s48, s69, 434176
    s_add_u32 s49, s71, 1024
    s_mov_b32 m0, s49
    s_nop 0
    buffer_load_dwordx4 v245, s[20:23], s48 offen lds
    s_cmp_lg_u32 s46, 0
    s_cbranch_scc1 Lpl_52
    s_mov_b32 s48, 0
    s_lshl_b32 s49, s44, 10
    s_add_u32 s49, s49, 49152
    v_lshl_add_u32 v251, v1, 6, s49
    s_mov_b64 exec, 0xffff
    buffer_load_dword v248, v251, s[40:43], 0 offen sc1
    buffer_load_dword v247, v251, s[40:43], 0 offen sc1
    buffer_load_dword v246, v251, s[40:43], 0 offen sc1
Lpp_53:
    buffer_load_dword v250, v251, s[40:43], 0 offen sc1
    s_waitcnt vmcnt(3)
    v_cmp_ne_u32 vcc, s47, v248
    s_cmp_eq_u64 vcc, 0
    s_cbranch_scc1 Lpd_54
    buffer_load_dword v248, v251, s[40:43], 0 offen sc1
    s_waitcnt vmcnt(3)
    v_cmp_ne_u32 vcc, s47, v247
    s_cmp_eq_u64 vcc, 0
    s_cbranch_scc1 Lpd_54
    buffer_load_dword v247, v251, s[40:43], 0 offen sc1
    s_waitcnt vmcnt(3)
    v_cmp_ne_u32 vcc, s47, v246
    s_cmp_eq_u64 vcc, 0
    s_cbranch_scc1 Lpd_54
    buffer_load_dword v246, v251, s[40:43], 0 offen sc1
    s_waitcnt vmcnt(3)
    v_cmp_ne_u32 vcc, s47, v250
    s_cmp_eq_u64 vcc, 0
    s_cbranch_scc1 Lpd_54
    s_add_u32 s48, s48, 1
    s_cmp_lt_u32 s48, 400000
    s_cbranch_scc1 Lpp_53
    Lpd_54:
    s_mov_b64 exec, -1
Lpl_52:
    s_waitcnt vmcnt(8)
    s_barrier
    buffer_load_dwordx4 v[48:51], v15, s[40:43], s72 offen offset:0 sc1
    buffer_load_dwordx4 v[52:55], v15, s[40:43], s76 offen offset:0 sc1
    buffer_load_dwordx4 v[56:59], v15, s[40:43], s72 offen offset:1024 sc1
    buffer_load_dwordx4 v[60:63], v15, s[40:43], s76 offen offset:1024 sc1
    buffer_load_dwordx4 v[64:67], v15, s[40:43], s72 offen offset:2048 sc1
    buffer_load_dwordx4 v[68:71], v15, s[40:43], s76 offen offset:2048 sc1
    buffer_load_dwordx2 v[72:73], v10, s[40:43], s72 offen offset:3072 sc1
    buffer_load_dwordx2 v[74:75], v10, s[40:43], s72 offen offset:3584 sc1
    buffer_load_dwordx2 v[76:77], v10, s[40:43], s76 offen offset:3072 sc1
    buffer_load_dwordx2 v[78:79], v10, s[40:43], s76 offen offset:3584 sc1
    s_waitcnt vmcnt(8)
    v_mfma_f32_16x16x32_bf16 v[16:19], v[160:163], v[48:51], 0
    v_mfma_f32_16x16x32_bf16 v[32:35], v[160:163], v[52:55], 0
    ds_read_b64_tr_b16 v[160:161], v6 offset:4096
    ds_read_b64_tr_b16 v[162:163], v6 offset:6144
    buffer_load_dwordx4 v[80:83], v15, s[40:43], s73 offen offset:0 sc1
    buffer_load_dwordx4 v[84:87], v15, s[40:43], s77 offen offset:0 sc1
    v_mfma_f32_16x16x32_bf16 v[20:23], v[164:167], v[48:51], 0
    v_mfma_f32_16x16x32_bf16 v[36:39], v[164:167], v[52:55], 0
    ds_read_b64_tr_b16 v[164:165], v7 offset:4096
    ds_read_b64_tr_b16 v[166:167], v7 offset:6144
    v_mfma_f32_16x16x32_bf16 v[24:27], v[168:171], v[48:51], 0
    v_mfma_f32_16x16x32_bf16 v[40:43], v[168:171], v[52:55], 0
    ds_read_b64_tr_b16 v[168:169], v8 offset:4096
    ds_read_b64_tr_b16 v[170:171], v8 offset:6144
    v_mfma_f32_16x16x32_bf16 v[28:31], v[172:175], v[48:51], 0
    v_mfma_f32_16x16x32_bf16 v[44:47], v[172:175], v[52:55], 0
    ds_read_b64_tr_b16 v[172:173], v9 offset:4096
    ds_read_b64_tr_b16 v[174:175], v9 offset:6144
    s_waitcnt vmcnt(8)
    v_mfma_f32_16x16x32_bf16 v[16:19], v[176:179], v[56:59], v[16:19]
    v_mfma_f32_16x16x32_bf16 v[32:35], v[176:179], v[60:63], v[32:35]
    ds_read_b64_tr_b16 v[176:177], v6 offset:8192
    ds_read_b64_tr_b16 v[178:179], v6 offset:10240
    buffer_load_dwordx4 v[88:91], v15, s[40:43], s73 offen offset:1024 sc1
    buffer_load_dwordx4 v[92:95], v15, s[40:43], s77 offen offset:1024 sc1
    v_mfma_f32_16x16x32_bf16 v[20:23], v[180:183], v[56:59], v[20:23]
    v_mfma_f32_16x16x32_bf16 v[36:39], v[180:183], v[60:63], v[36:39]
    ds_read_b64_tr_b16 v[180:181], v7 offset:8192
    ds_read_b64_tr_b16 v[182:183], v7 offset:10240
    v_mfma_f32_16x16x32_bf16 v[24:27], v[184:187], v[56:59], v[24:27]
    v_mfma_f32_16x16x32_bf16 v[40:43], v[184:187], v[60:63], v[40:43]
    ds_read_b64_tr_b16 v[184:185], v8 offset:8192
    ds_read_b64_tr_b16 v[186:187], v8 offset:10240
    v_mfma_f32_16x16x32_bf16 v[28:31], v[188:191], v[56:59], v[28:31]
    v_mfma_f32_16x16x32_bf16 v[44:47], v[188:191], v[60:63], v[44:47]
    ds_read_b64_tr_b16 v[188:189], v9 offset:8192
    ds_read_b64_tr_b16 v[190:191], v9 offset:10240
    s_waitcnt vmcnt(8)
    v_mfma_f32_16x16x32_bf16 v[16:19], v[192:195], v[64:67], v[16:19]
    v_mfma_f32_16x16x32_bf16 v[32:35], v[192:195], v[68:71], v[32:35]
    ds_read_b64_tr_b16 v[192:193], v6 offset:12288
    ds_read_b64_tr_b16 v[194:195], v6 offset:14336
    buffer_load_dwordx4 v[96:99], v15, s[40:43], s73 offen offset:2048 sc1
    buffer_load_dwordx4 v[100:103], v15, s[40:43], s77 offen offset:2048 sc1
    v_mfma_f32_16x16x32_bf16 v[20:23], v[196:199], v[64:67], v[20:23]
    v_mfma_f32_16x16x32_bf16 v[36:39], v[196:199], v[68:71], v[36:39]
    ds_read_b64_tr_b16 v[196:197], v7 offset:12288
    ds_read_b64_tr_b16 v[198:199], v7 offset:14336
    v_mfma_f32_16x16x32_bf16 v[24:27], v[200:203], v[64:67], v[24:27]
    v_mfma_f32_16x16x32_bf16 v[40:43], v[200:203], v[68:71], v[40:43]
    ds_read_b64_tr_b16 v[200:201], v8 offset:12288
    ds_read_b64_tr_b16 v[202:203], v8 offset:14336
    v_mfma_f32_16x16x32_bf16 v[28:31], v[204:207], v[64:67], v[28:31]
    v_mfma_f32_16x16x32_bf16 v[44:47], v[204:207], v[68:71], v[44:47]
    ds_read_b64_tr_b16 v[204:205], v9 offset:12288
    ds_read_b64_tr_b16 v[206:207], v9 offset:14336
    s_waitcnt vmcnt(6)
    v_mfma_f32_16x16x32_bf16 v[16:19], v[208:211], v[72:75], v[16:19]
    v_mfma_f32_16x16x32_bf16 v[32:35], v[208:211], v[76:79], v[32:35]
    ds_read_b64_tr_b16 v[208:209], v6 offset:16384
    ds_read_b64_tr_b16 v[210:211], v6 offset:18432
    buffer_load_dwordx4 v[104:107], v15, s[40:43], s73 offen offset:3072 sc1
    buffer_load_dwordx4 v[108:111], v15, s[40:43], s77 offen offset:3072 sc1
    v_mfma_f32_16x16x32_bf16 v[20:23], v[212:215], v[72:75], v[20:23]
    v_mfma_f32_16x16x32_bf16 v[36:39], v[212:215], v[76:79], v[36:39]
    ds_read_b64_tr_b16 v[212:213], v7 offset:16384
    ds_read_b64_tr_b16 v[214:215], v7 offset:18432
    v_mfma_f32_16x16x32_bf16 v[24:27], v[216:219], v[72:75], v[24:27]
    v_mfma_f32_16x16x32_bf16 v[40:43], v[216:219], v[76:79], v[40:43]
    ds_read_b64_tr_b16 v[216:217], v8 offset:16384
    ds_read_b64_tr_b16 v[218:219], v8 offset:18432
    v_mfma_f32_16x16x32_bf16 v[28:31], v[220:223], v[72:75], v[28:31]
    v_mfma_f32_16x16x32_bf16 v[44:47], v[220:223], v[76:79], v[44:47]
    ds_read_b64_tr_b16 v[220:221], v9 offset:16384
    ds_read_b64_tr_b16 v[222:223], v9 offset:18432
    s_waitcnt vmcnt(6) lgkmcnt(15)
    v_mfma_f32_16x16x32_bf16 v[16:19], v[160:163], v[80:83], v[16:19]
    v_mfma_f32_16x16x32_bf16 v[32:35], v[160:163], v[84:87], v[32:35]
    ds_read_b64_tr_b16 v[160:161], v6 offset:20480
    ds_read_b64_tr_b16 v[162:163], v6 offset:22528
    buffer_load_dwordx4 v[112:115], v15, s[40:43], s74 offen offset:0 sc1
    buffer_load_dwordx4 v[116:119], v15, s[40:43], s78 offen offset:0 sc1
    v_mfma_f32_16x16x32_bf16 v[20:23], v[164:167], v[80:83], v[20:23]
    v_mfma_f32_16x16x32_bf16 v[36:39], v[164:167], v[84:87], v[36:39]
    ds_read_b64_tr_b16 v[164:165], v7 offset:20480
    ds_read_b64_tr_b16 v[166:167], v7 offset:22528
    v_mfma_f32_16x16x32_bf16 v[24:27], v[168:171], v[80:83], v[24:27]
    v_mfma_f32_16x16x32_bf16 v[40:43], v[168:171], v[84:87], v[40:43]
    ds_read_b64_tr_b16 v[168:169], v8 offset:20480
    ds_read_b64_tr_b16 v[170:171], v8 offset:22528
    v_mfma_f32_16x16x32_bf16 v[28:31], v[172:175], v[80:83], v[28:31]
    v_mfma_f32_16x16x32_bf16 v[44:47], v[172:175], v[84:87], v[44:47]
    ds_read_b64_tr_b16 v[172:173], v9 offset:20480
    ds_read_b64_tr_b16 v[174:175], v9 offset:22528
    s_waitcnt vmcnt(6) lgkmcnt(15)
    v_mfma_f32_16x16x32_bf16 v[16:19], v[176:179], v[88:91], v[16:19]
    v_mfma_f32_16x16x32_bf16 v[32:35], v[176:179], v[92:95], v[32:35]
    ds_read_b64_tr_b16 v[176:177], v6 offset:24576
    ds_read_b64_tr_b16 v[178:179], v6 offset:26624
    buffer_load_dwordx4 v[120:123], v15, s[40:43], s74 offen offset:1024 sc1
    buffer_load_dwordx4 v[124:127], v15, s[40:43], s78 offen offset:1024 sc1
    v_mfma_f32_16x16x32_bf16 v[20:23], v[180:183], v[88:91], v[20:23]
    v_mfma_f32_16x16x32_bf16 v[36:39], v[180:183], v[92:95], v[36:39]
    ds_read_b64_tr_b16 v[180:181], v7 offset:24576
    ds_read_b64_tr_b16 v[182:183], v7 offset:26624
    v_mfma_f32_16x16x32_bf16 v[24:27], v[184:187], v[88:91], v[24:27]
    v_mfma_f32_16x16x32_bf16 v[40:43], v[184:187], v[92:95], v[40:43]
    ds_read_b64_tr_b16 v[184:185], v8 offset:24576
    ds_read_b64_tr_b16 v[186:187], v8 offset:26624
    v_mfma_f32_16x16x32_bf16 v[28:31], v[188:191], v[88:91], v[28:31]
    v_mfma_f32_16x16x32_bf16 v[44:47], v[188:191], v[92:95], v[44:47]
    ds_read_b64_tr_b16 v[188:189], v9 offset:24576
    ds_read_b64_tr_b16 v[190:191], v9 offset:26624
    s_waitcnt vmcnt(6) lgkmcnt(15)
    s_barrier
    v_mfma_f32_16x16x32_bf16 v[16:19], v[192:195], v[96:99], v[16:19]
    v_mfma_f32_16x16x32_bf16 v[32:35], v[192:195], v[100:103], v[32:35]
    ds_read_b64_tr_b16 v[192:193], v2 offset:0
    ds_read_b64_tr_b16 v[194:195], v2 offset:2048
    buffer_load_dwordx2 v[128:129], v10, s[40:43], s74 offen offset:2048 sc1
    buffer_load_dwordx2 v[130:131], v10, s[40:43], s74 offen offset:2560 sc1
    buffer_load_dwordx2 v[132:133], v10, s[40:43], s78 offen offset:2048 sc1
    buffer_load_dwordx2 v[134:135], v10, s[40:43], s78 offen offset:2560 sc1
    v_mfma_f32_16x16x32_bf16 v[20:23], v[196:199], v[96:99], v[20:23]
    v_mfma_f32_16x16x32_bf16 v[36:39], v[196:199], v[100:103], v[36:39]
    ds_read_b64_tr_b16 v[196:197], v3 offset:0
    ds_read_b64_tr_b16 v[198:199], v3 offset:2048
    v_mfma_f32_16x16x32_bf16 v[24:27], v[200:203], v[96:99], v[24:27]
    v_mfma_f32_16x16x32_bf16 v[40:43], v[200:203], v[100:103], v[40:43]
    ds_read_b64_tr_b16 v[200:201], v4 offset:0
    ds_read_b64_tr_b16 v[202:203], v4 offset:2048
    v_mfma_f32_16x16x32_bf16 v[28:31], v[204:207], v[96:99], v[28:31]
    v_mfma_f32_16x16x32_bf16 v[44:47], v[204:207], v[100:103], v[44:47]
    ds_read_b64_tr_b16 v[204:205], v5 offset:0
    ds_read_b64_tr_b16 v[206:207], v5 offset:2048
    s_waitcnt vmcnt(8) lgkmcnt(15)
    v_mfma_f32_16x16x32_bf16 v[16:19], v[208:211], v[104:107], v[16:19]
    v_mfma_f32_16x16x32_bf16 v[32:35], v[208:211], v[108:111], v[32:35]
    ds_read_b64_tr_b16 v[208:209], v2 offset:4096
    ds_read_b64_tr_b16 v[210:211], v2 offset:6144
    buffer_load_dwordx4 v[136:139], v15, s[40:43], s74 offen offset:3072 sc1
    buffer_load_dwordx4 v[140:143], v15, s[40:43], s78 offen offset:3072 sc1
    v_mfma_f32_16x16x32_bf16 v[20:23], v[212:215], v[104:107], v[20:23]
    v_mfma_f32_16x16x32_bf16 v[36:39], v[212:215], v[108:111], v[36:39]
    ds_read_b64_tr_b16 v[212:213], v3 offset:4096
    ds_read_b64_tr_b16 v[214:215], v3 offset:6144
    v_mfma_f32_16x16x32_bf16 v[24:27], v[216:219], v[104:107], v[24:27]
    v_mfma_f32_16x16x32_bf16 v[40:43], v[216:219], v[108:111], v[40:43]
    ds_read_b64_tr_b16 v[216:217], v4 offset:4096
    ds_read_b64_tr_b16 v[218:219], v4 offset:6144
    v_mfma_f32_16x16x32_bf16 v[28:31], v[220:223], v[104:107], v[28:31]
    v_mfma_f32_16x16x32_bf16 v[44:47], v[220:223], v[108:111], v[44:47]
    ds_read_b64_tr_b16 v[220:221], v5 offset:4096
    ds_read_b64_tr_b16 v[222:223], v5 offset:6144
    s_waitcnt vmcnt(8) lgkmcnt(15)
    v_mfma_f32_16x16x32_bf16 v[16:19], v[160:163], v[112:115], v[16:19]
    v_mfma_f32_16x16x32_bf16 v[32:35], v[160:163], v[116:119], v[32:35]
    ds_read_b64_tr_b16 v[160:161], v2 offset:8192
    ds_read_b64_tr_b16 v[162:163], v2 offset:10240
    buffer_load_dwordx4 v[144:147], v15, s[40:43], s75 offen offset:0 sc1
    buffer_load_dwordx4 v[148:151], v15, s[40:43], s79 offen offset:0 sc1
    v_mfma_f32_16x16x32_bf16 v[20:23], v[164:167], v[112:115], v[20:23]
    v_mfma_f32_16x16x32_bf16 v[36:39], v[164:167], v[116:119], v[36:39]
    ds_read_b64_tr_b16 v[164:165], v3 offset:8192
    ds_read_b64_tr_b16 v[166:167], v3 offset:10240
    v_mfma_f32_16x16x32_bf16 v[24:27], v[168:171], v[112:115], v[24:27]
    v_mfma_f32_16x16x32_bf16 v[40:43], v[168:171], v[116:119], v[40:43]
    ds_read_b64_tr_b16 v[168:169], v4 offset:8192
    ds_read_b64_tr_b16 v[170:171], v4 offset:10240
    v_mfma_f32_16x16x32_bf16 v[28:31], v[172:175], v[112:115], v[28:31]
    v_mfma_f32_16x16x32_bf16 v[44:47], v[172:175], v[116:119], v[44:47]
    ds_read_b64_tr_b16 v[172:173], v5 offset:8192
    ds_read_b64_tr_b16 v[174:175], v5 offset:10240
    s_waitcnt vmcnt(8) lgkmcnt(15)
    v_mfma_f32_16x16x32_bf16 v[16:19], v[176:179], v[120:123], v[16:19]
    v_mfma_f32_16x16x32_bf16 v[32:35], v[176:179], v[124:127], v[32:35]
    ds_read_b64_tr_b16 v[176:177], v6 offset:0
    ds_read_b64_tr_b16 v[178:179], v6 offset:2048
    buffer_load_dwordx4 v[152:155], v15, s[40:43], s75 offen offset:1024 sc1
    buffer_load_dwordx4 v[156:159], v15, s[40:43], s79 offen offset:1024 sc1
    v_mfma_f32_16x16x32_bf16 v[20:23], v[180:183], v[120:123], v[20:23]
    v_mfma_f32_16x16x32_bf16 v[36:39], v[180:183], v[124:127], v[36:39]
    ds_read_b64_tr_b16 v[180:181], v7 offset:0
    ds_read_b64_tr_b16 v[182:183], v7 offset:2048
    v_mfma_f32_16x16x32_bf16 v[24:27], v[184:187], v[120:123], v[24:27]
    v_mfma_f32_16x16x32_bf16 v[40:43], v[184:187], v[124:127], v[40:43]
    ds_read_b64_tr_b16 v[184:185], v8 offset:0
    ds_read_b64_tr_b16 v[186:187], v8 offset:2048
    v_mfma_f32_16x16x32_bf16 v[28:31], v[188:191], v[120:123], v[28:31]
    v_mfma_f32_16x16x32_bf16 v[44:47], v[188:191], v[124:127], v[44:47]
    ds_read_b64_tr_b16 v[188:189], v9 offset:0
    ds_read_b64_tr_b16 v[190:191], v9 offset:2048
    s_waitcnt vmcnt(6) lgkmcnt(15)
    v_mfma_f32_16x16x32_bf16 v[16:19], v[192:195], v[128:131], v[16:19]
    v_mfma_f32_16x16x32_bf16 v[32:35], v[192:195], v[132:135], v[32:35]
    v_mfma_f32_16x16x32_bf16 v[20:23], v[196:199], v[128:131], v[20:23]
    v_mfma_f32_16x16x32_bf16 v[36:39], v[196:199], v[132:135], v[36:39]
    v_mfma_f32_16x16x32_bf16 v[24:27], v[200:203], v[128:131], v[24:27]
    v_mfma_f32_16x16x32_bf16 v[40:43], v[200:203], v[132:135], v[40:43]
    v_mfma_f32_16x16x32_bf16 v[28:31], v[204:207], v[128:131], v[28:31]
    v_mfma_f32_16x16x32_bf16 v[44:47], v[204:207], v[132:135], v[44:47]
    s_waitcnt vmcnt(4) lgkmcnt(15)
    v_mfma_f32_16x16x32_bf16 v[16:19], v[208:211], v[136:139], v[16:19]
    v_mfma_f32_16x16x32_bf16 v[32:35], v[208:211], v[140:143], v[32:35]
    v_mfma_f32_16x16x32_bf16 v[20:23], v[212:215], v[136:139], v[20:23]
    v_mfma_f32_16x16x32_bf16 v[36:39], v[212:215], v[140:143], v[36:39]
    v_mfma_f32_16x16x32_bf16 v[24:27], v[216:219], v[136:139], v[24:27]
    v_mfma_f32_16x16x32_bf16 v[40:43], v[216:219], v[140:143], v[40:43]
    v_mfma_f32_16x16x32_bf16 v[28:31], v[220:223], v[136:139], v[28:31]
    v_mfma_f32_16x16x32_bf16 v[44:47], v[220:223], v[140:143], v[44:47]
    s_waitcnt vmcnt(2) lgkmcnt(8)
    v_mfma_f32_16x16x32_bf16 v[16:19], v[160:163], v[144:147], v[16:19]
    v_mfma_f32_16x16x32_bf16 v[32:35], v[160:163], v[148:151], v[32:35]
    v_mfma_f32_16x16x32_bf16 v[20:23], v[164:167], v[144:147], v[20:23]
    v_mfma_f32_16x16x32_bf16 v[36:39], v[164:167], v[148:151], v[36:39]
    v_mfma_f32_16x16x32_bf16 v[24:27], v[168:171], v[144:147], v[24:27]
    v_mfma_f32_16x16x32_bf16 v[40:43], v[168:171], v[148:151], v[40:43]
    v_mfma_f32_16x16x32_bf16 v[28:31], v[172:175], v[144:147], v[28:31]
    v_mfma_f32_16x16x32_bf16 v[44:47], v[172:175], v[148:151], v[44:47]
    s_waitcnt vmcnt(0) lgkmcnt(0)
    v_mfma_f32_16x16x32_bf16 v[16:19], v[176:179], v[152:155], v[16:19]
    v_mfma_f32_16x16x32_bf16 v[32:35], v[176:179], v[156:159], v[32:35]
    v_mfma_f32_16x16x32_bf16 v[20:23], v[180:183], v[152:155], v[20:23]
    v_mfma_f32_16x16x32_bf16 v[36:39], v[180:183], v[156:159], v[36:39]
    v_mfma_f32_16x16x32_bf16 v[24:27], v[184:187], v[152:155], v[24:27]
    v_mfma_f32_16x16x32_bf16 v[40:43], v[184:187], v[156:159], v[40:43]
    v_mfma_f32_16x16x32_bf16 v[28:31], v[188:191], v[152:155], v[28:31]
    v_mfma_f32_16x16x32_bf16 v[44:47], v[188:191], v[156:159], v[44:47]
    s_lshl_b32 s48, s88, 13
    s_lshl_b32 s49, s86, 12
    s_add_u32 s48, s48, s49
    s_lshl_b32 s49, s90, 11
    s_add_u32 s48, s48, s49
    v_add_u32 v13, s48, v15
    s_barrier
    v_lshrrev_b32 v10, 4, v1
    v_lshlrev_b32 v11, 3, v10
    v_sub_u32 v244, v244, v11
    v_and_b32 v11, 1, v10
    v_lshl_add_u32 v244, v11, 5, v244
    v_lshrrev_b32 v11, 1, v10
    v_lshl_add_u32 v244, v11, 4, v244
    s_lshl_b32 s48, s46, 13
    s_add_u32 s48, s48, 0
    v_add_u32 v12, s48, v15
    ds_write_b128 v12, v[16:19] offset:0
    ds_write_b128 v12, v[20:23] offset:1024
    ds_write_b128 v12, v[24:27] offset:2048
    ds_write_b128 v12, v[28:31] offset:3072
    ds_write_b128 v12, v[32:35] offset:4096
    ds_write_b128 v12, v[36:39] offset:5120
    ds_write_b128 v12, v[40:43] offset:6144
    ds_write_b128 v12, v[44:47] offset:7168
    s_waitcnt lgkmcnt(0)
    s_barrier
    ds_read_b128 v[48:51], v13 offset:0
    ds_read_b128 v[52:55], v13 offset:1024
    ds_read_b128 v[56:59], v13 offset:16384
    ds_read_b128 v[60:63], v13 offset:17408
    ds_read_b128 v[64:67], v13 offset:32768
    ds_read_b128 v[68:71], v13 offset:33792
    ds_read_b128 v[72:75], v13 offset:49152
    ds_read_b128 v[76:79], v13 offset:50176
    s_waitcnt lgkmcnt(4)
    v_add_f32 v48, v48, v56
    v_add_f32 v49, v49, v57
    v_add_f32 v50, v50, v58
    v_add_f32 v51, v51, v59
    v_add_f32 v52, v52, v60
    v_add_f32 v53, v53, v61
    v_add_f32 v54, v54, v62
    v_add_f32 v55, v55, v63
    s_waitcnt lgkmcnt(2)
    v_add_f32 v48, v48, v64
    v_add_f32 v49, v49, v65
    v_add_f32 v50, v50, v66
    v_add_f32 v51, v51, v67
    v_add_f32 v52, v52, v68
    v_add_f32 v53, v53, v69
    v_add_f32 v54, v54, v70
    v_add_f32 v55, v55, v71
    s_waitcnt lgkmcnt(0)
    v_add_f32 v48, v48, v72
    v_add_f32 v49, v49, v73
    v_add_f32 v50, v50, v74
    v_add_f32 v51, v51, v75
    v_add_f32 v52, v52, v76
    v_add_f32 v53, v53, v77
    v_add_f32 v54, v54, v78
    v_add_f32 v55, v55, v79
    v_lshlrev_b32 v64, 16, v224
    v_and_b32 v65, 0xffff0000, v224
    v_lshlrev_b32 v66, 16, v225
    v_and_b32 v67, 0xffff0000, v225
    v_lshlrev_b32 v68, 16, v226
    v_and_b32 v69, 0xffff0000, v226
    v_lshlrev_b32 v70, 16, v227
    v_and_b32 v71, 0xffff0000, v227
    v_add_f32 v48, v48, v64
    v_add_f32 v48, v48, v228
    v_add_f32 v49, v49, v65
    v_add_f32 v49, v49, v229
    v_add_f32 v50, v50, v66
    v_add_f32 v50, v50, v230
    v_add_f32 v51, v51, v67
    v_add_f32 v51, v51, v231
    v_add_f32 v52, v52, v68
    v_add_f32 v52, v52, v232
    v_add_f32 v53, v53, v69
    v_add_f32 v53, v53, v233
    v_add_f32 v54, v54, v70
    v_add_f32 v54, v54, v234
    v_add_f32 v55, v55, v71
    v_add_f32 v55, v55, v235
    v_cvt_pk_bf16_f32 v56, v48, v49
    v_cvt_pk_bf16_f32 v57, v50, v51
    v_cvt_pk_bf16_f32 v58, v52, v53
    v_cvt_pk_bf16_f32 v59, v54, v55
    s_nop 1
    v_permlane16_swap_b32 v56, v58
    v_permlane16_swap_b32 v57, v59
    buffer_store_dwordx4 v[56:59], v244, s[32:35], 0 offen
Lend:
    s_endpgm
.section .rodata,"a"
.p2align 6
.amdhsa_kernel sequential_preLN__sliding_block__dense_activation_squared_relu__prompt_kernel
  .amdhsa_next_free_vgpr 256
  .amdhsa_next_free_sgpr 102
  .amdhsa_accum_offset 256
  .amdhsa_group_segment_fixed_size 0
  .amdhsa_kernarg_size 88
  .amdhsa_user_sgpr_count 2
  .amdhsa_user_sgpr_kernarg_segment_ptr 1
  .amdhsa_system_sgpr_workgroup_id_x 1
.end_amdhsa_kernel
```
